```python
import torch

def _softmax(x, axis=-1):
    return torch.softmax(x, dim=axis)
def _gelu(x):
    return torch.nn.functional.gelu(x, approximate="tanh")
def _silu(x):
    return torch.nn.functional.silu(x)
def _sigmoid(x):
    return torch.sigmoid(x)
def _layernorm(x, axis=-1, eps=1e-5):
    m = x.mean(dim=axis, keepdim=True)
    v = x.var(dim=axis, keepdim=True, unbiased=False)
    return (x - m) / torch.sqrt(v + eps)
def _scatter_add(tgt, idx, src, axis=0):
    return tgt.clone().index_add_(axis, idx, src)
def _segment_sum(src, seg, n):
    out = torch.zeros((n,) + src.shape[1:], dtype=src.dtype)
    return out.index_add_(0, seg, src)
def _pad(x, pw):
    flat = tuple(v for pair in reversed(pw) for v in pair)
    return torch.nn.functional.pad(x, flat)

kernel_name = 'parallel_sum__ssm_conv_h3__dense_activation_relu__prompt'

def setup_inputs():

    _w = (lambda a: (lambda t: t.to(torch.bfloat16) if t.is_floating_point() else t)(torch.as_tensor(a)))
    def _A_setup():
        B, S, D = 1, 2048, 512
        ks = 4
        return {
            "q": _w((lambda *s: torch.randn(*s, dtype=torch.bfloat16) * 0.05)(B, S, D)),
            "k": _w((lambda *s: torch.randn(*s, dtype=torch.bfloat16) * 0.8)(B, S, D)),
            "v": _w((lambda *s: torch.randn(*s, dtype=torch.bfloat16) * 0.4)(B, S, D)),
            "shift_k": _w((lambda *s: torch.randn(*s, dtype=torch.bfloat16) * 0.8)(D, ks) * 0.5),
            "ssm_k": _w((lambda *s: torch.randn(*s, dtype=torch.bfloat16) * 0.8)(D, S) * (1.0 / S ** 0.5)),
            "ssm_D": _w((lambda *s: torch.randn(*s, dtype=torch.bfloat16) * 0.4)(D)),
        }
    _A_in = _A_setup()

    def _B_setup():
        B, S, D, Dff = 1, 2048, 512, 1792
        return {
            "x": _w((lambda *s: torch.randn(*s, dtype=torch.bfloat16) * 0.05)(B, S, D)),
            "w1": _w((lambda *s: torch.randn(*s, dtype=torch.bfloat16) * 0.05)(D, Dff)),
            "w2": _w((lambda *s: torch.randn(*s, dtype=torch.bfloat16) * 0.05)(Dff, D)),
        }
    _B_in = _B_setup()

    return {
        "A_q": _A_in["q"],
        "A_k": _A_in["k"],
        "A_v": _A_in["v"],
        "A_shift_k": _A_in["shift_k"],
        "A_ssm_k": _A_in["ssm_k"],
        "A_ssm_D": _A_in["ssm_D"],
        "B_x": _B_in["x"],
        "B_w1": _B_in["w1"],
        "B_w2": _B_in["w2"],
    }

def reference(A_q, A_k, A_v, A_shift_k, A_ssm_k, A_ssm_D, B_x, B_w1, B_w2):
    def _A_ref(q, k, v, shift_k, ssm_k, ssm_D):
        B, S, D = q.shape
        ks = shift_k.shape[-1]
        k_pad = _pad(k, ((0, 0), (ks - 1, 0), (0, 0)))
        k_shift = torch.zeros_like(k)
        for t in range(ks):
            k_shift = k_shift + k_pad[:, t:t + S, :] * shift_k[:, ks - 1 - t][None, None, :]
        kv = k_shift * v
        L = 2 * S
        kv_pad = _pad(kv, ((0, 0), (0, S), (0, 0)))
        kf_pad = _pad(ssm_k, ((0, 0), (0, S)))
        kv_f = (lambda x, axes=(-2,-1): torch.fft.rfft2(x.float(), dim=axes))(kv_pad[:, None, :, :], axes=(1, 2))
        kf_f = (lambda x, axes=(-2,-1): torch.fft.rfft2(x.float(), dim=axes))(kf_pad[:, None, :], axes=(1, 2))
        kf_f = (lambda x, *d: x.permute(*d))(kf_f, 1, 2, 0)
        y_f = kv_f * kf_f[None, :, :, :]
        y = (lambda x, s, axes=(-2,-1): torch.fft.irfft2(x, s=s, dim=axes).to(torch.bfloat16))(y_f, (1, L), axes=(1, 2))[:, 0, :S, :]
        y = y + kv * ssm_D[None, None, :]
        return q * y

    def _B_ref(x, w1, w2):
        h = torch.einsum("bsd,df->bsf", x, w1)
        zero = torch.zeros_like(h)
        h = torch.maximum(h, zero)
        return torch.einsum("bsf,fd->bsd", h, w2)

    x = A_q
    xn = _layernorm(x, axis=-1)
    return x + _A_ref(xn, A_k, A_v, A_shift_k, A_ssm_k, A_ssm_D) + _B_ref(xn, B_w1, B_w2)
```

```asm
; @launch grid=(256,1,1) block=(512,1,1) lds=163840
.amdgcn_target "amdgcn-amd-amdhsa--gfx950"
.text
.globl parallel_sum__ssm_conv_h3__dense_activation_relu__prompt_kernel
.p2align 8
.type parallel_sum__ssm_conv_h3__dense_activation_relu__prompt_kernel,@function
parallel_sum__ssm_conv_h3__dense_activation_relu__prompt_kernel:
    s_cmp_ge_u32 s2, 256
    s_cbranch_scc1 L_end
    s_load_dwordx16 s[4:19], s[0:1], 0
    s_load_dwordx8 s[20:27], s[0:1], 64
    v_lshrrev_b32 v2, 6, v0
    v_and_b32 v1, 63, v0
    v_readfirstlane_b32 s56, v2
    s_and_b32 s58, s2, 7
    s_lshr_b32 s59, s2, 3
    s_add_u32 s59, s59, 28
    s_and_b32 s59, s59, 31
    s_and_b32 s60, s59, 3
    s_and_b32 s64, s58, 6
    s_lshl_b32 s64, s64, 1
    s_add_u32 s60, s60, s64
    s_and_b32 s64, s58, 1
    s_mul_i32 s64, s64, 7
    s_lshr_b32 s61, s59, 2
    s_add_u32 s61, s61, s64
    s_and_b32 s62, s59, 7
    s_and_b32 s64, s58, 6
    s_lshl_b32 s64, s64, 2
    s_add_u32 s62, s62, s64
    s_and_b32 s64, s58, 1
    s_lshl_b32 s64, s64, 2
    s_lshr_b32 s63, s59, 3
    s_add_u32 s63, s63, s64
    s_cmp_lt_u32 s59, 28
    s_cselect_b32 s82, 1, 0
    s_and_b32 s57, s56, 3
    s_lshl_b32 s71, s58, 5
    s_add_u32 s71, s71, s59
    s_cmp_ge_u32 s56, 4
    s_cbranch_scc1 L_helper
    v_lshrrev_b32 v184, 3, v1
    v_and_b32 v191, 7, v1
    v_lshlrev_b32 v184, 10, v184
    v_lshl_add_u32 v184, v191, 4, v184
    s_lshl_b32 s64, s59, 16
    s_lshl_b32 s65, s57, 14
    s_add_u32 s64, s64, s65
    s_lshl_b32 s65, s58, 7
    s_add_u32 s64, s64, s65
    v_add_u32 v184, s64, v184
    v_subrev_u32 v185, 0x2000, v184
    s_mul_i32 s70, s57, 5120
    s_add_u32 s70, s70, 143360
    s_lshl_b32 s65, s58, 9
    v_lshl_add_u32 v186, v1, 3, s65
    s_lshl_b32 s65, s71, 2
    s_setprio 3
    s_mov_b32 m0, s70
    s_movk_i32 s66, 0x1c00
    s_waitcnt lgkmcnt(0)
    s_mov_b32 s28, s6
    s_mov_b32 s29, s7
    s_mov_b32 s30, 0x200000
    s_mov_b32 s31, 0x20000
    buffer_load_dwordx4 v185, s[28:31], 0 offen nt lds
    s_add_u32 m0, s70, 1024
    s_mov_b32 s32, s8
    s_mov_b32 s33, s9
    s_mov_b32 s34, 0x200000
    s_mov_b32 s35, 0x20000
    buffer_load_dwordx4 v184, s[28:31], 0 offen nt lds
    buffer_load_dwordx4 v184, s[28:31], s66 offen offset:1024 nt lds
    s_mov_b32 s40, s10
    s_mov_b32 s41, s11
    s_mov_b32 s42, 0x1000
    s_mov_b32 s43, 0x20000
    buffer_load_dwordx2 v[188:189], v186, s[40:43], 0 offen
    s_add_u32 m0, s70, 3072
    s_load_dword s75, s[14:15], s65
    buffer_load_dwordx4 v184, s[32:35], 0 offen nt lds
    buffer_load_dwordx4 v184, s[32:35], s66 offen offset:1024 nt lds
    s_mov_b32 s36, s26
    s_mov_b32 s37, s27
    s_mov_b32 s38, 0x1000000
    s_mov_b32 s39, 0x20000
    v_min_u32 v27, 1, v1
    v_lshlrev_b32 v28, 31, v27
    v_lshlrev_b32 v26, 4, v1
    s_mov_b32 s73, 0xd40000
    s_load_dwordx2 s[88:89], s[26:27], s73
    s_mov_b32 s48, s22
    s_mov_b32 s49, s23
    s_mov_b32 s50, 0x200000
    s_mov_b32 s51, 0x20000
    s_mov_b32 s40, s4
    s_mov_b32 s41, s5
    s_mov_b32 s42, 0x200000
    s_mov_b32 s43, 0x20000
    v_bfe_u32 v8, v1, 2, 2
    v_lshrrev_b32 v9, 4, v1
    v_and_b32 v10, 3, v1
    v_and_b32 v20, 15, v1
    v_lshlrev_b32 v187, 7, v8
    v_lshl_add_u32 v187, v9, 5, v187
    v_lshl_add_u32 v187, v10, 3, v187
    v_add_u32 v187, s70, v187
    s_lshl_b32 s64, s57, 1
    s_sub_u32 s64, 6, s64
    v_xor_b32 v191, s64, v191
    v_lshlrev_b32 v190, 7, v1
    v_lshl_add_u32 v190, v191, 4, v190
    v_add_u32 v190, 131584, v190
    v_xor_b32 v191, 16, v190
    s_lshr_b32 s64, s57, 1
    s_and_b32 s65, s57, 1
    v_lshrrev_b32 v21, 1, v20
    v_xor_b32 v21, v21, v9
    v_lshlrev_b32 v22, 7, v20
    v_lshl_add_u32 v12, v21, 4, v22
    s_lshl_b32 s66, s57, 12
    v_add_u32 v12, s66, v12
    v_xor_b32 v13, 0x1000, v12
    v_xor_b32 v14, 64, v12
    v_xor_b32 v15, 64, v13
    v_and_b32 v21, 1, v9
    v_lshl_or_b32 v21, v21, 2, v8
    s_lshl_b32 s66, s65, 1
    s_add_u32 s66, s66, s64
    s_lshl_b32 s66, s66, 1
    v_xor_b32 v21, s66, v21
    v_lshl_add_u32 v22, v9, 3, v8
    v_lshlrev_b32 v22, 8, v22
    v_lshl_add_u32 v22, v10, 3, v22
    v_add_u32 v22, 0x4000, v22
    v_xor_b32 v23, 0, v21
    v_lshl_add_u32 v16, v23, 5, v22
    v_xor_b32 v23, 1, v21
    v_lshl_add_u32 v17, v23, 5, v22
    v_xor_b32 v23, 2, v21
    v_lshl_add_u32 v18, v23, 5, v22
    v_xor_b32 v23, 3, v21
    v_lshl_add_u32 v19, v23, 5, v22
    s_lshl_b32 s66, s60, 1
    s_add_u32 s66, s66, s64
    s_mul_i32 s67, s66, 14
    s_add_u32 s67, s67, s61
    s_lshl_b32 s67, s67, 3
    s_mul_i32 s84, s65, 6
    s_add_u32 s67, s67, s84
    s_add_u32 s67, s67, s64
    s_lshl_b32 s67, s67, 11
    s_add_u32 s84, s67, 0x400000
    s_xor_b32 s85, s84, 0x800
    s_xor_b32 s86, s84, 0x2000
    s_xor_b32 s87, s84, 0x2800
    s_lshl_b32 s76, s66, 6
    s_and_b32 s67, s59, 28
    s_add_u32 s76, s76, s67
    v_lshrrev_b32 v11, 1, v1
    v_min_u32 v11, 1, v11
    v_lshlrev_b32 v11, 31, v11
    v_mul_u32_u24 v27, 224, v1
    v_or_b32 v11, v11, v27
    s_and_b32 s67, s58, 1
    s_lshl_b32 s67, s67, 1
    s_add_u32 s76, s76, s67
    s_add_u32 s76, s76, s65
    s_lshl_b32 s76, s76, 3
    s_add_u32 s76, s76, 0xd10000
    s_lshl_b32 s66, s57, 10
    s_add_u32 s66, s66, 143360
    v_lshl_add_u32 v21, v1, 2, s66
    v_xor_b32 v22, 0x400, v21
    v_xor_b32 v23, 0x800, v21
    v_mov_b32 v24, 0xbb000000
    v_cmp_gt_u32 vcc, 16, v1
    v_lshrrev_b32 v27, 5, v1
    v_bfe_u32 v220, v1, 1, 1
    v_cndmask_b32 v24, 0, v24, vcc
    v_cmp_eq_u32 vcc, v27, v220
    v_mov_b32 v27, 0x3f803f80
    v_and_b32 v220, 1, v1
    v_cndmask_b32 v192, 0, v27, vcc
    v_cndmask_b32 v193, 0, v27, vcc
    v_cndmask_b32 v194, 0, v27, vcc
    v_cndmask_b32 v195, 0, v27, vcc
    v_mul_u32_u24 v25, 0xaaaa, v220
    v_add_u32 v25, 0x4444, v25
    v_mov_b32 v29, 140800
    v_mov_b64 v[64:65], 0
    v_mov_b64 v[66:67], 0
    v_mov_b64 v[68:69], 0
    v_mov_b64 v[70:71], 0
    v_mov_b64 v[72:73], 0
    v_mov_b64 v[74:75], 0
    v_mov_b64 v[76:77], 0
    v_mov_b64 v[78:79], 0
    v_mov_b64 v[80:81], 0
    v_mov_b64 v[82:83], 0
    v_mov_b64 v[84:85], 0
    v_mov_b64 v[86:87], 0
    v_mov_b64 v[88:89], 0
    v_mov_b64 v[90:91], 0
    v_mov_b64 v[92:93], 0
    v_mov_b64 v[94:95], 0
    v_mov_b64 v[96:97], 0
    v_mov_b64 v[98:99], 0
    v_mov_b64 v[100:101], 0
    v_mov_b64 v[102:103], 0
    v_mov_b64 v[104:105], 0
    v_mov_b64 v[106:107], 0
    v_mov_b64 v[108:109], 0
    v_mov_b64 v[110:111], 0
    v_mov_b64 v[112:113], 0
    v_mov_b64 v[114:115], 0
    v_mov_b64 v[116:117], 0
    v_mov_b64 v[118:119], 0
    v_mov_b64 v[120:121], 0
    v_mov_b64 v[122:123], 0
    v_mov_b64 v[124:125], 0
    v_mov_b64 v[126:127], 0
    v_mov_b64 v[196:197], 0
    v_mov_b64 v[198:199], 0
    v_mov_b64 v[200:201], 0
    v_mov_b64 v[202:203], 0
    v_mov_b64 v[204:205], 0
    v_mov_b64 v[206:207], 0
    v_mov_b64 v[208:209], 0
    v_mov_b64 v[210:211], 0
    v_mov_b64 v[212:213], 0
    v_mov_b64 v[214:215], 0
    v_mov_b64 v[216:217], 0
    v_mov_b64 v[218:219], 0
    v_and_b32 v27, 3, v20
    v_sub_u32 v27, 3, v27
    v_mul_u32_u24 v27, 4160, v27
    v_lshrrev_b32 v4, 2, v20
    v_lshl_add_u32 v4, v4, 3, v27
    v_lshl_add_u32 v4, v9, 4, v4
    s_lshr_b32 s64, s57, 1
    s_and_b32 s65, s57, 1
    s_mul_i32 s66, s64, 16640
    s_lshl_b32 s67, s65, 8
    s_add_u32 s66, s66, s67
    s_add_u32 s66, s66, 98312
    v_add_u32 v4, s66, v4
    s_mul_i32 s66, s64, 4608
    s_add_u32 s67, s67, s66
    s_add_u32 s67, s67, 132064
    v_lshlrev_b32 v27, 5, v20
    v_lshlrev_b32 v5, 4, v9
    v_sub_u32 v5, v5, v27
    v_add_u32 v5, s67, v5
    s_lshl_b32 s67, s65, 11
    s_sub_u32 s66, s66, s67
    s_add_u32 s66, s66, 134136
    v_lshl_add_u32 v6, v9, 3, v27
    v_sub_u32 v6, s66, v6
    s_lshl_b32 s66, s57, 12
    s_add_u32 s66, s66, 147456
    v_lshl_add_u32 v7, v1, 4, s66
    v_xor_b32 v8, 0x1000, v7
    v_lshrrev_b32 v10, 3, v20
    v_lshl_add_u32 v10, v9, 1, v10
    v_lshlrev_b32 v10, 16, v10
    v_and_b32 v27, 7, v20
    v_lshl_add_u32 v10, v27, 4, v10
    s_mov_b32 s74, 0
    s_mov_b32 s68, 0x1e11e11
    v_lshrrev_b32 v2, 3, v1
    v_and_b32 v3, 7, v1
    v_xor_b32 v27, v2, v3
    v_lshlrev_b32 v30, 7, v2
    v_lshl_add_u32 v30, v27, 4, v30
    s_lshl_b32 s64, s57, 11
    s_add_u32 s64, s64, 131584
    v_add_u32 v30, s64, v30
    v_lshlrev_b32 v31, 12, v2
    v_lshl_add_u32 v31, v3, 4, v31
    s_lshl_b32 s64, s58, 2
    s_add_u32 s64, s64, s57
    s_lshl_b32 s92, s64, 5
    s_sub_u32 s65, 31, s59
    s_add_u32 s92, s92, s65
    s_lshl_b32 s64, s64, 16
    s_lshl_b32 s65, s65, 7
    s_add_u32 s90, s64, s65
    s_add_u32 s91, s90, 0x8000
    s_lshl_b32 s92, s92, 3
    s_add_u32 s92, s92, 0xd00000
    s_waitcnt vmcnt(2)
    ds_read_b64_tr_b16 v[128:129], v187 offset:512
    ds_read_b64_tr_b16 v[130:131], v187 offset:1024
    ds_read_b64_tr_b16 v[132:133], v187 offset:1536
    ds_read_b64_tr_b16 v[134:135], v187 offset:2048
    ds_read_b64_tr_b16 v[136:137], v187 offset:2560
    v_alignbyte_b32 v146, v189, v189, 2
    v_alignbyte_b32 v147, v188, v188, 2
    v_and_b32 v148, 0xffff0000, v189
    s_mov_b32 s64, 0xffff
    v_bfi_b32 v149, s64, v189, v188
    v_and_b32 v150, 0xffff, v188
    s_waitcnt lgkmcnt(0)
    v_dot2_f32_bf16 v152, v128, v148, 0
    v_dot2_f32_bf16 v153, v129, v146, 0
    v_dot2_f32_bf16 v154, v129, v148, 0
    v_dot2_f32_bf16 v155, v130, v146, 0
    v_dot2_f32_bf16 v156, v130, v148, 0
    v_dot2_f32_bf16 v157, v131, v146, 0
    v_dot2_f32_bf16 v158, v131, v148, 0
    v_dot2_f32_bf16 v159, v132, v146, 0
    v_dot2_f32_bf16 v160, v132, v148, 0
    v_dot2_f32_bf16 v161, v133, v146, 0
    v_dot2_f32_bf16 v162, v133, v148, 0
    v_dot2_f32_bf16 v163, v134, v146, 0
    v_dot2_f32_bf16 v164, v134, v148, 0
    v_dot2_f32_bf16 v165, v135, v146, 0
    v_dot2_f32_bf16 v166, v135, v148, 0
    v_dot2_f32_bf16 v167, v136, v146, 0
    v_dot2_f32_bf16 v152, v129, v149, v152
    v_dot2_f32_bf16 v153, v130, v147, v153
    v_dot2_f32_bf16 v154, v130, v149, v154
    v_dot2_f32_bf16 v155, v131, v147, v155
    v_dot2_f32_bf16 v156, v131, v149, v156
    v_dot2_f32_bf16 v157, v132, v147, v157
    v_dot2_f32_bf16 v158, v132, v149, v158
    v_dot2_f32_bf16 v159, v133, v147, v159
    v_dot2_f32_bf16 v160, v133, v149, v160
    v_dot2_f32_bf16 v161, v134, v147, v161
    v_dot2_f32_bf16 v162, v134, v149, v162
    v_dot2_f32_bf16 v163, v135, v147, v163
    v_dot2_f32_bf16 v164, v135, v149, v164
    v_dot2_f32_bf16 v165, v136, v147, v165
    v_dot2_f32_bf16 v166, v136, v149, v166
    v_dot2_f32_bf16 v167, v137, v147, v167
    s_waitcnt vmcnt(0)
    ds_read_b64_tr_b16 v[138:139], v187 offset:3072
    ds_read_b64_tr_b16 v[140:141], v187 offset:3584
    ds_read_b64_tr_b16 v[142:143], v187 offset:4096
    ds_read_b64_tr_b16 v[144:145], v187 offset:4608
    s_add_u32 s88, s88, 0x7f4a7c15
    s_add_u32 s89, s89, 0x9e3779b9
    v_mov_b32 v2, s88
    v_mov_b32 v3, s89
    v_dot2_f32_bf16 v152, v130, v150, v152
    v_dot2_f32_bf16 v154, v131, v150, v154
    v_dot2_f32_bf16 v156, v132, v150, v156
    v_dot2_f32_bf16 v158, v133, v150, v158
    v_dot2_f32_bf16 v160, v134, v150, v160
    v_dot2_f32_bf16 v162, v135, v150, v162
    v_dot2_f32_bf16 v164, v136, v150, v164
    v_dot2_f32_bf16 v166, v137, v150, v166
    s_waitcnt lgkmcnt(0)
    v_lshlrev_b32 v176, 16, v142
    v_and_b32 v177, 0xffff0000, v142
    v_lshlrev_b32 v178, 16, v143
    v_and_b32 v179, 0xffff0000, v143
    v_lshlrev_b32 v180, 16, v144
    v_and_b32 v181, 0xffff0000, v144
    v_lshlrev_b32 v182, 16, v145
    v_and_b32 v183, 0xffff0000, v145
    v_pk_mul_f32 v[160:161], v[160:161], v[176:177]
    v_pk_mul_f32 v[162:163], v[162:163], v[178:179]
    v_pk_mul_f32 v[164:165], v[164:165], v[180:181]
    v_pk_mul_f32 v[166:167], v[166:167], v[182:183]
    v_cvt_pk_bf16_f32 v128, v167, v166
    v_cvt_pk_bf16_f32 v129, v165, v164
    v_cvt_pk_bf16_f32 v130, v163, v162
    v_cvt_pk_bf16_f32 v131, v161, v160
    ds_write_b128 v190, v[128:131]
    v_lshlrev_b32 v168, 16, v138
    v_and_b32 v169, 0xffff0000, v138
    v_lshlrev_b32 v170, 16, v139
    v_and_b32 v171, 0xffff0000, v139
    v_lshlrev_b32 v172, 16, v140
    v_and_b32 v173, 0xffff0000, v140
    v_lshlrev_b32 v174, 16, v141
    v_and_b32 v175, 0xffff0000, v141
    v_pk_mul_f32 v[152:153], v[152:153], v[168:169]
    v_pk_mul_f32 v[154:155], v[154:155], v[170:171]
    v_pk_mul_f32 v[156:157], v[156:157], v[172:173]
    v_pk_mul_f32 v[158:159], v[158:159], v[174:175]
    v_cvt_pk_bf16_f32 v132, v159, v158
    v_cvt_pk_bf16_f32 v133, v157, v156
    v_cvt_pk_bf16_f32 v134, v155, v154
    v_cvt_pk_bf16_f32 v135, v153, v152
    ds_write_b128 v191, v[132:135]
    s_waitcnt lgkmcnt(0)
    s_barrier
    ds_read_b128 v[48:51], v30
    ds_read_b128 v[52:55], v30 offset:1024
    s_waitcnt lgkmcnt(1)
    buffer_store_dwordx4 v[48:51], v31, s[36:39], s90 offen sc1
    s_waitcnt lgkmcnt(0)
    buffer_store_dwordx4 v[52:55], v31, s[36:39], s91 offen sc1
    s_cmp_eq_u32 s82, 0
    s_barrier
    s_cbranch_scc1 L_spare_m
    ds_read_b64_tr_b16 v[128:129], v16 offset:0
    ds_read_b64_tr_b16 v[130:131], v16 offset:1024
    ds_read_b128 v[144:147], v12 offset:0
    ds_read_b64_tr_b16 v[132:133], v17 offset:0
    ds_read_b64_tr_b16 v[134:135], v17 offset:1024
    ds_read_b128 v[148:151], v12 offset:2048
    ds_read_b64_tr_b16 v[136:137], v18 offset:0
    ds_read_b64_tr_b16 v[138:139], v18 offset:1024
    ds_read_b128 v[152:155], v13 offset:0
    ds_read_b64_tr_b16 v[140:141], v19 offset:0
    ds_read_b64_tr_b16 v[142:143], v19 offset:1024
    ds_read_b128 v[156:159], v13 offset:2048
L_g1:
    s_waitcnt lgkmcnt(9)
    v_mfma_f32_16x16x32_bf16 v[64:67], v[128:131], v[144:147], v[64:67]
    ds_read_b64_tr_b16 v[160:161], v16 offset:8192
    s_bfe_i32 s65, s68, 0x40000
    s_waitcnt lgkmcnt(7)
    v_mfma_f32_16x16x32_bf16 v[80:83], v[132:135], v[144:147], v[80:83]
    ds_read_b64_tr_b16 v[162:163], v16 offset:9216
    s_lshr_b32 s68, s68, 4
    v_mfma_f32_16x16x32_bf16 v[68:71], v[128:131], v[148:151], v[68:71]
    ds_read_b128 v[176:179], v14 offset:0
    s_lshl_b32 s65, s65, 15
    v_mfma_f32_16x16x32_bf16 v[84:87], v[132:135], v[148:151], v[84:87]
    ds_read_b64_tr_b16 v[164:165], v17 offset:8192
    s_add_u32 s74, s74, 1
    v_smfmac_f32_16x16x64_bf16 v[196:199], v[192:195], v[144:151], v25
    ds_read_b64_tr_b16 v[166:167], v17 offset:9216
    s_cmp_eq_u32 s74, 8
    v_smfmac_f32_16x16x64_bf16 v[200:203], v[192:195], v[128:135], v25
    ds_read_b128 v[180:183], v14 offset:2048
    s_waitcnt lgkmcnt(9)
    v_mfma_f32_16x16x32_bf16 v[96:99], v[136:139], v[144:147], v[96:99]
    ds_read_b64_tr_b16 v[168:169], v18 offset:8192
    v_mfma_f32_16x16x32_bf16 v[100:103], v[136:139], v[148:151], v[100:103]
    ds_read_b64_tr_b16 v[170:171], v18 offset:9216
    v_mfma_f32_16x16x32_bf16 v[72:75], v[128:131], v[152:155], v[72:75]
    ds_read_b128 v[184:187], v15 offset:0
    v_mfma_f32_16x16x32_bf16 v[88:91], v[132:135], v[152:155], v[88:91]
    ds_read_b64_tr_b16 v[172:173], v19 offset:8192
    v_mfma_f32_16x16x32_bf16 v[104:107], v[136:139], v[152:155], v[104:107]
    ds_read_b64_tr_b16 v[174:175], v19 offset:9216
    s_waitcnt lgkmcnt(11)
    v_mfma_f32_16x16x32_bf16 v[112:115], v[140:143], v[144:147], v[112:115]
    ds_read_b128 v[188:191], v15 offset:2048
    v_mfma_f32_16x16x32_bf16 v[116:119], v[140:143], v[148:151], v[116:119]
    v_add_u32 v12, s65, v12
    v_add_u32 v13, s65, v13
    v_mfma_f32_16x16x32_bf16 v[120:123], v[140:143], v[152:155], v[120:123]
    v_add_u32 v14, s65, v14
    v_add_u32 v15, s65, v15
    v_mfma_f32_16x16x32_bf16 v[76:79], v[128:131], v[156:159], v[76:79]
    v_add_u32 v16, s65, v16
    v_add_u32 v17, s65, v17
    v_mfma_f32_16x16x32_bf16 v[92:95], v[132:135], v[156:159], v[92:95]
    v_add_u32 v18, s65, v18
    v_add_u32 v19, s65, v19
    v_mfma_f32_16x16x32_bf16 v[108:111], v[136:139], v[156:159], v[108:111]
    v_mfma_f32_16x16x32_bf16 v[124:127], v[140:143], v[156:159], v[124:127]
    s_cbranch_scc1 L_g1_last
    s_waitcnt lgkmcnt(9)
    v_mfma_f32_16x16x32_bf16 v[64:67], v[160:163], v[176:179], v[64:67]
    s_waitcnt lgkmcnt(6)
    v_mfma_f32_16x16x32_bf16 v[80:83], v[164:167], v[176:179], v[80:83]
    v_mfma_f32_16x16x32_bf16 v[68:71], v[160:163], v[180:183], v[68:71]
    v_mfma_f32_16x16x32_bf16 v[84:87], v[164:167], v[180:183], v[84:87]
    v_smfmac_f32_16x16x64_bf16 v[196:199], v[192:195], v[176:183], v25
    v_smfmac_f32_16x16x64_bf16 v[200:203], v[192:195], v[160:167], v25
    s_cmp_lg_u32 s74, 3
    s_cbranch_scc1 L_noflag
    s_waitcnt vmcnt(0)
    buffer_store_dwordx2 v[2:3], v28, s[36:39], s92 offen sc1
L_noflag:
    s_waitcnt lgkmcnt(0)
    s_barrier
    v_mfma_f32_16x16x32_bf16 v[96:99], v[168:171], v[176:179], v[96:99]
    ds_read_b64_tr_b16 v[128:129], v16 offset:0
    v_mfma_f32_16x16x32_bf16 v[100:103], v[168:171], v[180:183], v[100:103]
    ds_read_b64_tr_b16 v[130:131], v16 offset:1024
    v_mfma_f32_16x16x32_bf16 v[72:75], v[160:163], v[184:187], v[72:75]
    ds_read_b128 v[144:147], v12 offset:0
    v_mfma_f32_16x16x32_bf16 v[88:91], v[164:167], v[184:187], v[88:91]
    ds_read_b64_tr_b16 v[132:133], v17 offset:0
    v_mfma_f32_16x16x32_bf16 v[104:107], v[168:171], v[184:187], v[104:107]
    ds_read_b64_tr_b16 v[134:135], v17 offset:1024
    v_mfma_f32_16x16x32_bf16 v[112:115], v[172:175], v[176:179], v[112:115]
    ds_read_b128 v[148:151], v12 offset:2048
    v_mfma_f32_16x16x32_bf16 v[116:119], v[172:175], v[180:183], v[116:119]
    ds_read_b64_tr_b16 v[136:137], v18 offset:0
    v_mfma_f32_16x16x32_bf16 v[120:123], v[172:175], v[184:187], v[120:123]
    ds_read_b64_tr_b16 v[138:139], v18 offset:1024
    v_mfma_f32_16x16x32_bf16 v[76:79], v[160:163], v[188:191], v[76:79]
    ds_read_b128 v[152:155], v13 offset:0
    v_mfma_f32_16x16x32_bf16 v[92:95], v[164:167], v[188:191], v[92:95]
    ds_read_b64_tr_b16 v[140:141], v19 offset:0
    v_mfma_f32_16x16x32_bf16 v[108:111], v[168:171], v[188:191], v[108:111]
    ds_read_b64_tr_b16 v[142:143], v19 offset:1024
    v_mfma_f32_16x16x32_bf16 v[124:127], v[172:175], v[188:191], v[124:127]
    ds_read_b128 v[156:159], v13 offset:2048
    s_branch L_g1
L_g1_last:
    s_waitcnt lgkmcnt(6)
    v_smfmac_f32_16x16x64_bf16 v[196:199], v[192:195], v[176:183], v25
    s_nop 1
    v_smfmac_f32_16x16x64_bf16 v[200:203], v[192:195], v[160:167], v25
    s_nop 1
    v_mfma_f32_16x16x32_bf16 v[64:67], v[160:163], v[176:179], v[64:67]
    s_nop 1
    v_mfma_f32_16x16x32_bf16 v[80:83], v[164:167], v[176:179], v[80:83]
    s_nop 1
    v_mfma_f32_16x16x32_bf16 v[68:71], v[160:163], v[180:183], v[68:71]
    v_add_f32 v220, v196, v197
    v_add_f32 v221, v198, v199
    v_mfma_f32_16x16x32_bf16 v[84:87], v[164:167], v[180:183], v[84:87]
    v_mul_f32 v220, v24, v220
    v_mul_f32 v221, v24, v221
    s_waitcnt lgkmcnt(3)
    v_mfma_f32_16x16x32_bf16 v[72:75], v[160:163], v[184:187], v[72:75]
    v_add_f32 v222, v200, v201
    v_add_f32 v223, v202, v203
    v_mfma_f32_16x16x32_bf16 v[88:91], v[164:167], v[184:187], v[88:91]
    v_cvt_pk_bf16_f32 v204, v220, v220
    v_cvt_pk_bf16_f32 v206, v221, v221
    s_waitcnt lgkmcnt(0)
    v_mfma_f32_16x16x32_bf16 v[76:79], v[160:163], v[188:191], v[76:79]
    v_cvt_pk_bf16_f32 v224, v222, v223
    ds_write2st64_b32 v21, v204, v206 offset0:0 offset1:1
    v_mfma_f32_16x16x32_bf16 v[92:95], v[164:167], v[188:191], v[92:95]
    v_lshlrev_b32 v225, 16, v224
    v_and_b32 v226, 0xffff0000, v224
    v_mfma_f32_16x16x32_bf16 v[96:99], v[168:171], v[176:179], v[96:99]
    v_sub_f32 v225, v222, v225
    v_sub_f32 v226, v223, v226
    v_mfma_f32_16x16x32_bf16 v[112:115], v[172:175], v[176:179], v[112:115]
    v_cvt_pk_bf16_f32 v212, v222, v225
    v_cvt_pk_bf16_f32 v214, v223, v226
    v_mfma_f32_16x16x32_bf16 v[100:103], v[168:171], v[180:183], v[100:103]
    ds_write2st64_b32 v21, v212, v214 offset0:2 offset1:3
    v_mfma_f32_16x16x32_bf16 v[116:119], v[172:175], v[180:183], v[116:119]
    v_mfma_f32_16x16x32_bf16 v[104:107], v[168:171], v[184:187], v[104:107]
    s_waitcnt lgkmcnt(0)
    s_barrier
    v_mfma_f32_16x16x32_bf16 v[120:123], v[172:175], v[184:187], v[120:123]
    ds_read_b32 v208, v22
    ds_read_b32 v210, v22 offset:256
    v_mfma_f32_16x16x32_bf16 v[108:111], v[168:171], v[188:191], v[108:111]
    v_mfma_f32_16x16x32_bf16 v[124:127], v[172:175], v[188:191], v[124:127]
    v_mfma_f32_16x16x16bf16_1k v[64:67], v[212:213], v[204:205], v[64:67]
    ds_read_b32 v216, v23 offset:512
    ds_read_b32 v218, v23 offset:768
    v_mfma_f32_16x16x16bf16_1k v[80:83], v[214:215], v[204:205], v[80:83]
    s_nop 1
    v_mfma_f32_16x16x16bf16_1k v[68:71], v[212:213], v[206:207], v[68:71]
    v_mfma_f32_16x16x16bf16_1k v[84:87], v[214:215], v[206:207], v[84:87]
    s_waitcnt lgkmcnt(0)
    v_mfma_f32_16x16x16bf16_1k v[72:75], v[212:213], v[208:209], v[72:75]
    v_cvt_pk_bf16_f32 v48, v64, v65
    v_cvt_pk_bf16_f32 v49, v66, v67
    v_cvt_pk_bf16_f32 v50, v80, v81
    v_cvt_pk_bf16_f32 v51, v82, v83
    v_mfma_f32_16x16x16bf16_1k v[88:91], v[214:215], v[208:209], v[88:91]
    v_pk_max_i16 v48, v48, 0
    v_pk_max_i16 v49, v49, 0
    v_pk_max_i16 v50, v50, 0
    v_pk_max_i16 v51, v51, 0
    buffer_store_dwordx4 v[48:51], v26, s[36:39], s84 offen offset:0 sc1
    v_mfma_f32_16x16x16bf16_1k v[76:79], v[212:213], v[210:211], v[76:79]
    v_cvt_pk_bf16_f32 v52, v68, v69
    v_cvt_pk_bf16_f32 v53, v70, v71
    v_cvt_pk_bf16_f32 v54, v84, v85
    v_cvt_pk_bf16_f32 v55, v86, v87
    v_mfma_f32_16x16x16bf16_1k v[92:95], v[214:215], v[210:211], v[92:95]
    v_pk_max_i16 v52, v52, 0
    v_pk_max_i16 v53, v53, 0
    v_pk_max_i16 v54, v54, 0
    v_pk_max_i16 v55, v55, 0
    buffer_store_dwordx4 v[52:55], v26, s[36:39], s84 offen offset:1024 sc1
    v_mfma_f32_16x16x16bf16_1k v[96:99], v[216:217], v[204:205], v[96:99]
    v_cvt_pk_bf16_f32 v56, v72, v73
    v_cvt_pk_bf16_f32 v57, v74, v75
    v_cvt_pk_bf16_f32 v58, v88, v89
    v_cvt_pk_bf16_f32 v59, v90, v91
    v_mfma_f32_16x16x16bf16_1k v[112:115], v[218:219], v[204:205], v[112:115]
    v_pk_max_i16 v56, v56, 0
    v_pk_max_i16 v57, v57, 0
    v_pk_max_i16 v58, v58, 0
    v_pk_max_i16 v59, v59, 0
    buffer_store_dwordx4 v[56:59], v26, s[36:39], s86 offen offset:0 sc1
    v_mfma_f32_16x16x16bf16_1k v[100:103], v[216:217], v[206:207], v[100:103]
    v_cvt_pk_bf16_f32 v60, v76, v77
    v_cvt_pk_bf16_f32 v61, v78, v79
    v_cvt_pk_bf16_f32 v62, v92, v93
    v_cvt_pk_bf16_f32 v63, v94, v95
    v_mfma_f32_16x16x16bf16_1k v[116:119], v[218:219], v[206:207], v[116:119]
    v_pk_max_i16 v60, v60, 0
    v_pk_max_i16 v61, v61, 0
    v_pk_max_i16 v62, v62, 0
    v_pk_max_i16 v63, v63, 0
    buffer_store_dwordx4 v[60:63], v26, s[36:39], s86 offen offset:1024 sc1
    v_mfma_f32_16x16x16bf16_1k v[104:107], v[216:217], v[208:209], v[104:107]
    v_cvt_pk_bf16_f32 v48, v96, v97
    v_cvt_pk_bf16_f32 v49, v98, v99
    v_cvt_pk_bf16_f32 v50, v112, v113
    v_cvt_pk_bf16_f32 v51, v114, v115
    v_mfma_f32_16x16x16bf16_1k v[120:123], v[218:219], v[208:209], v[120:123]
    v_pk_max_i16 v48, v48, 0
    v_pk_max_i16 v49, v49, 0
    v_pk_max_i16 v50, v50, 0
    v_pk_max_i16 v51, v51, 0
    buffer_store_dwordx4 v[48:51], v26, s[36:39], s85 offen offset:0 sc1
    v_mfma_f32_16x16x16bf16_1k v[108:111], v[216:217], v[210:211], v[108:111]
    v_cvt_pk_bf16_f32 v52, v100, v101
    v_cvt_pk_bf16_f32 v53, v102, v103
    v_cvt_pk_bf16_f32 v54, v116, v117
    v_cvt_pk_bf16_f32 v55, v118, v119
    v_mfma_f32_16x16x16bf16_1k v[124:127], v[218:219], v[210:211], v[124:127]
    v_pk_max_i16 v52, v52, 0
    v_pk_max_i16 v53, v53, 0
    v_pk_max_i16 v54, v54, 0
    v_pk_max_i16 v55, v55, 0
    buffer_store_dwordx4 v[52:55], v26, s[36:39], s85 offen offset:1024 sc1
    v_cvt_pk_bf16_f32 v56, v104, v105
    v_cvt_pk_bf16_f32 v57, v106, v107
    v_cvt_pk_bf16_f32 v58, v120, v121
    v_cvt_pk_bf16_f32 v59, v122, v123
    v_pk_max_i16 v56, v56, 0
    v_pk_max_i16 v57, v57, 0
    v_pk_max_i16 v58, v58, 0
    v_pk_max_i16 v59, v59, 0
    buffer_store_dwordx4 v[56:59], v26, s[36:39], s87 offen offset:0 sc1
    ds_read_b32 v27, v29 offset:8
    v_cvt_pk_bf16_f32 v60, v108, v109
    v_cvt_pk_bf16_f32 v61, v110, v111
    v_cvt_pk_bf16_f32 v62, v124, v125
    v_cvt_pk_bf16_f32 v63, v126, v127
    v_pk_max_i16 v60, v60, 0
    v_pk_max_i16 v61, v61, 0
    v_pk_max_i16 v62, v62, 0
    v_pk_max_i16 v63, v63, 0
    buffer_store_dwordx4 v[60:63], v26, s[36:39], s87 offen offset:1024 sc1
L_m_rchk:
    s_mov_b32 s67, 0
L_rl_1:
    s_waitcnt lgkmcnt(0)
    v_readfirstlane_b32 s64, v27
    s_add_u32 s67, s67, 1
    s_cmp_ge_u32 s64, 4
    s_cbranch_scc1 L_rd_2
    s_cmp_gt_u32 s67, 0x100000
    s_cbranch_scc1 L_rd_2
    ds_read_b32 v27, v29 offset:8
    s_branch L_rl_1
L_rd_2:
    ds_read_b64 v[128:129], v4 offset:0
    ds_read_b64 v[130:131], v4 offset:8
    ds_read_b128 v[160:163], v5 offset:3584
    ds_read_b128 v[164:167], v5 offset:3072
    ds_read_b128 v[168:171], v5 offset:2560
    ds_read_b128 v[172:175], v5 offset:2048
    ds_read_b128 v[176:179], v5 offset:1536
    ds_read_b128 v[180:183], v5 offset:1024
    ds_read_b128 v[184:187], v5 offset:512
    ds_read_b128 v[188:191], v5 offset:0
    ds_read_b64 v[132:133], v4 offset:512
    ds_read_b64 v[134:135], v4 offset:520
    ds_read_b64 v[136:137], v4 offset:1024
    ds_read_b64 v[138:139], v4 offset:1032
L_m_conv:
    s_waitcnt lgkmcnt(11)
    v_mfma_f32_16x16x32_bf16 v[64:67], v[128:131], v[160:163], 0
    ds_read_b64 v[140:141], v4 offset:1536
    ds_read_b64 v[142:143], v4 offset:1544
    s_waitcnt lgkmcnt(12)
    v_mfma_f32_16x16x32_bf16 v[68:71], v[128:131], v[164:167], 0
    ds_read_b64 v[144:145], v4 offset:2048
    ds_read_b64 v[146:147], v4 offset:2056
    s_waitcnt lgkmcnt(13)
    v_mfma_f32_16x16x32_bf16 v[72:75], v[128:131], v[168:171], 0
    ds_read_b64 v[148:149], v4 offset:2560
    ds_read_b64 v[150:151], v4 offset:2568
    s_waitcnt lgkmcnt(14)
    v_mfma_f32_16x16x32_bf16 v[76:79], v[128:131], v[172:175], 0
    ds_read_b64 v[152:153], v4 offset:3072
    ds_read_b64 v[154:155], v4 offset:3080
    s_waitcnt lgkmcnt(14)
    v_mfma_f32_16x16x32_bf16 v[80:83], v[128:131], v[176:179], 0
    ds_read_b64 v[156:157], v4 offset:3584
    v_mfma_f32_16x16x32_bf16 v[84:87], v[128:131], v[180:183], 0
    ds_read_b64 v[158:159], v4 offset:3592
    s_waitcnt lgkmcnt(14)
    v_mfma_f32_16x16x32_bf16 v[88:91], v[128:131], v[184:187], 0
    ds_read_b64 v[192:193], v4 offset:64
    v_mfma_f32_16x16x32_bf16 v[92:95], v[128:131], v[188:191], 0
    ds_read_b64 v[194:195], v4 offset:72
    s_waitcnt lgkmcnt(14)
    v_mfma_f32_16x16x32_bf16 v[68:71], v[132:135], v[160:163], v[68:71]
    ds_read_b128 v[96:99], v5 offset:3648
    v_mfma_f32_16x16x32_bf16 v[72:75], v[132:135], v[164:167], v[72:75]
    ds_read_b128 v[100:103], v5 offset:3136
    v_mfma_f32_16x16x32_bf16 v[76:79], v[132:135], v[168:171], v[76:79]
    ds_read_b128 v[104:107], v5 offset:2624
    v_mfma_f32_16x16x32_bf16 v[80:83], v[132:135], v[172:175], v[80:83]
    ds_read_b128 v[108:111], v5 offset:2112
    v_mfma_f32_16x16x32_bf16 v[84:87], v[132:135], v[176:179], v[84:87]
    ds_read_b128 v[112:115], v5 offset:1600
    v_mfma_f32_16x16x32_bf16 v[88:91], v[132:135], v[180:183], v[88:91]
    ds_read_b128 v[116:119], v5 offset:1088
    v_mfma_f32_16x16x32_bf16 v[92:95], v[132:135], v[184:187], v[92:95]
    ds_read_b128 v[120:123], v5 offset:576
    s_waitcnt lgkmcnt(14)
    v_mfma_f32_16x16x32_bf16 v[72:75], v[136:139], v[160:163], v[72:75]
    ds_read_b128 v[124:127], v5 offset:64
    v_mfma_f32_16x16x32_bf16 v[76:79], v[136:139], v[164:167], v[76:79]
    ds_read_b64 v[196:197], v4 offset:576
    v_mfma_f32_16x16x32_bf16 v[80:83], v[136:139], v[168:171], v[80:83]
    ds_read_b64 v[198:199], v4 offset:584
    v_mfma_f32_16x16x32_bf16 v[84:87], v[136:139], v[172:175], v[84:87]
    ds_read_b64 v[200:201], v4 offset:1088
    v_mfma_f32_16x16x32_bf16 v[88:91], v[136:139], v[176:179], v[88:91]
    ds_read_b64 v[202:203], v4 offset:1096
    v_mfma_f32_16x16x32_bf16 v[92:95], v[136:139], v[180:183], v[92:95]
    ds_read_b64 v[204:205], v4 offset:1600
    v_mfma_f32_16x16x32_bf16 v[76:79], v[140:143], v[160:163], v[76:79]
    ds_read_b64 v[206:207], v4 offset:1608
    v_mfma_f32_16x16x32_bf16 v[80:83], v[140:143], v[164:167], v[80:83]
    ds_read_b64 v[208:209], v4 offset:2112
    v_mfma_f32_16x16x32_bf16 v[84:87], v[140:143], v[168:171], v[84:87]
    ds_read_b64 v[210:211], v4 offset:2120
    v_mfma_f32_16x16x32_bf16 v[88:91], v[140:143], v[172:175], v[88:91]
    ds_read_b64 v[212:213], v4 offset:2624
    v_mfma_f32_16x16x32_bf16 v[92:95], v[140:143], v[176:179], v[92:95]
    ds_read_b64 v[214:215], v4 offset:2632
    v_mfma_f32_16x16x32_bf16 v[80:83], v[144:147], v[160:163], v[80:83]
    ds_read_b64 v[216:217], v4 offset:3136
    v_mfma_f32_16x16x32_bf16 v[84:87], v[144:147], v[164:167], v[84:87]
    ds_read_b64 v[218:219], v4 offset:3144
    v_mfma_f32_16x16x32_bf16 v[88:91], v[144:147], v[168:171], v[88:91]
    ds_read_b64 v[220:221], v4 offset:3648
    v_mfma_f32_16x16x32_bf16 v[92:95], v[144:147], v[172:175], v[92:95]
    ds_read_b64 v[222:223], v4 offset:3656
    s_waitcnt lgkmcnt(14)
    v_mfma_f32_16x16x32_bf16 v[84:87], v[148:151], v[160:163], v[84:87]
    v_mfma_f32_16x16x32_bf16 v[88:91], v[148:151], v[164:167], v[88:91]
    v_mfma_f32_16x16x32_bf16 v[92:95], v[148:151], v[168:171], v[92:95]
    v_mfma_f32_16x16x32_bf16 v[88:91], v[152:155], v[160:163], v[88:91]
    v_mfma_f32_16x16x32_bf16 v[92:95], v[152:155], v[164:167], v[92:95]
    v_mfma_f32_16x16x32_bf16 v[92:95], v[156:159], v[160:163], v[92:95]
    s_waitcnt lgkmcnt(0)
    v_mfma_f32_16x16x32_bf16 v[64:67], v[192:195], v[96:99], v[64:67]
    ds_read_b64 v[128:129], v4 offset:128
    v_mfma_f32_16x16x32_bf16 v[68:71], v[192:195], v[100:103], v[68:71]
    ds_read_b64 v[130:131], v4 offset:136
    v_mfma_f32_16x16x32_bf16 v[72:75], v[192:195], v[104:107], v[72:75]
    ds_read_b128 v[160:163], v5 offset:3712
    v_mfma_f32_16x16x32_bf16 v[76:79], v[192:195], v[108:111], v[76:79]
    ds_read_b128 v[164:167], v5 offset:3200
    v_mfma_f32_16x16x32_bf16 v[80:83], v[192:195], v[112:115], v[80:83]
    ds_read_b128 v[168:171], v5 offset:2688
    v_mfma_f32_16x16x32_bf16 v[84:87], v[192:195], v[116:119], v[84:87]
    ds_read_b128 v[172:175], v5 offset:2176
    v_mfma_f32_16x16x32_bf16 v[88:91], v[192:195], v[120:123], v[88:91]
    ds_read_b128 v[176:179], v5 offset:1664
    v_mfma_f32_16x16x32_bf16 v[92:95], v[192:195], v[124:127], v[92:95]
    ds_read_b128 v[180:183], v5 offset:1152
    v_mfma_f32_16x16x32_bf16 v[68:71], v[196:199], v[96:99], v[68:71]
    ds_read_b128 v[184:187], v5 offset:640
    v_mfma_f32_16x16x32_bf16 v[72:75], v[196:199], v[100:103], v[72:75]
    ds_read_b128 v[188:191], v5 offset:128
    v_mfma_f32_16x16x32_bf16 v[76:79], v[196:199], v[104:107], v[76:79]
    ds_read_b64 v[132:133], v4 offset:640
    v_mfma_f32_16x16x32_bf16 v[80:83], v[196:199], v[108:111], v[80:83]
    ds_read_b64 v[134:135], v4 offset:648
    v_mfma_f32_16x16x32_bf16 v[84:87], v[196:199], v[112:115], v[84:87]
    ds_read_b64 v[136:137], v4 offset:1152
    v_mfma_f32_16x16x32_bf16 v[88:91], v[196:199], v[116:119], v[88:91]
    ds_read_b64 v[138:139], v4 offset:1160
    v_mfma_f32_16x16x32_bf16 v[92:95], v[196:199], v[120:123], v[92:95]
    ds_read_b64 v[140:141], v4 offset:1664
    v_mfma_f32_16x16x32_bf16 v[72:75], v[200:203], v[96:99], v[72:75]
    ds_read_b64 v[142:143], v4 offset:1672
    v_mfma_f32_16x16x32_bf16 v[76:79], v[200:203], v[100:103], v[76:79]
    ds_read_b64 v[144:145], v4 offset:2176
    v_mfma_f32_16x16x32_bf16 v[80:83], v[200:203], v[104:107], v[80:83]
    ds_read_b64 v[146:147], v4 offset:2184
    v_mfma_f32_16x16x32_bf16 v[84:87], v[200:203], v[108:111], v[84:87]
    ds_read_b64 v[148:149], v4 offset:2688
    v_mfma_f32_16x16x32_bf16 v[88:91], v[200:203], v[112:115], v[88:91]
    ds_read_b64 v[150:151], v4 offset:2696
    v_mfma_f32_16x16x32_bf16 v[92:95], v[200:203], v[116:119], v[92:95]
    ds_read_b64 v[152:153], v4 offset:3200
    v_mfma_f32_16x16x32_bf16 v[76:79], v[204:207], v[96:99], v[76:79]
    ds_read_b64 v[154:155], v4 offset:3208
    v_mfma_f32_16x16x32_bf16 v[80:83], v[204:207], v[100:103], v[80:83]
    ds_read_b64 v[156:157], v4 offset:3712
    v_mfma_f32_16x16x32_bf16 v[84:87], v[204:207], v[104:107], v[84:87]
    ds_read_b64 v[158:159], v4 offset:3720
    v_mfma_f32_16x16x32_bf16 v[88:91], v[204:207], v[108:111], v[88:91]
    v_mfma_f32_16x16x32_bf16 v[92:95], v[204:207], v[112:115], v[92:95]
    v_mfma_f32_16x16x32_bf16 v[80:83], v[208:211], v[96:99], v[80:83]
    v_mfma_f32_16x16x32_bf16 v[84:87], v[208:211], v[100:103], v[84:87]
    v_mfma_f32_16x16x32_bf16 v[88:91], v[208:211], v[104:107], v[88:91]
    s_cmp_eq_u32 s82, 0
    s_cbranch_scc1 L_hf_3
    s_waitcnt vmcnt(0)
    buffer_store_dwordx2 v[2:3], v11, s[36:39], s76 offen sc1
L_hf_3:
    v_mfma_f32_16x16x32_bf16 v[92:95], v[208:211], v[108:111], v[92:95]
    v_mfma_f32_16x16x32_bf16 v[84:87], v[212:215], v[96:99], v[84:87]
    v_mfma_f32_16x16x32_bf16 v[88:91], v[212:215], v[100:103], v[88:91]
    v_mfma_f32_16x16x32_bf16 v[92:95], v[212:215], v[104:107], v[92:95]
    v_mfma_f32_16x16x32_bf16 v[88:91], v[216:219], v[96:99], v[88:91]
    v_mfma_f32_16x16x32_bf16 v[92:95], v[216:219], v[100:103], v[92:95]
    v_mfma_f32_16x16x32_bf16 v[92:95], v[220:223], v[96:99], v[92:95]
    s_waitcnt lgkmcnt(0)
    v_mfma_f32_16x16x32_bf16 v[64:67], v[128:131], v[160:163], v[64:67]
    ds_read_b64 v[192:193], v4 offset:192
    s_and_b32 s65, s57, 1
    s_lshr_b32 s64, s57, 1
    v_bfe_u32 v27, v1, 2, 2
    v_mfma_f32_16x16x32_bf16 v[68:71], v[128:131], v[164:167], v[68:71]
    ds_read_b64 v[194:195], v4 offset:200
    v_lshl_add_u32 v30, v9, 2, v27
    v_bfe_u32 v27, v30, 1, 2
    v_lshlrev_b32 v30, 7, v30
    v_mfma_f32_16x16x32_bf16 v[72:75], v[128:131], v[168:171], v[72:75]
    ds_read_b128 v[96:99], v5 offset:3776
    v_lshl_add_u32 v27, v27, 5, v30
    v_and_b32 v30, 3, v1
    s_lshl_b32 s66, s64, 14
    v_mfma_f32_16x16x32_bf16 v[76:79], v[128:131], v[172:175], v[76:79]
    ds_read_b128 v[100:103], v5 offset:3264
    v_lshl_add_u32 v27, v30, 3, v27
    v_add_u32 v32, s66, v27
    v_xor_b32 v33, 32, v32
    v_mfma_f32_16x16x32_bf16 v[80:83], v[128:131], v[176:179], v[80:83]
    ds_read_b128 v[104:107], v5 offset:2752
    v_xor_b32 v34, 64, v32
    v_xor_b32 v35, 0x60, v32
    v_add_u32 v36, 0x10000, v32
    v_mfma_f32_16x16x32_bf16 v[84:87], v[128:131], v[180:183], v[84:87]
    ds_read_b128 v[108:111], v5 offset:2240
    v_add_u32 v37, 0x10000, v33
    v_add_u32 v38, 0x10000, v34
    v_add_u32 v39, 0x10000, v35
    v_mfma_f32_16x16x32_bf16 v[88:91], v[128:131], v[184:187], v[88:91]
    ds_read_b128 v[112:115], v5 offset:1728
    v_lshrrev_b32 v40, 1, v9
    v_and_b32 v41, 7, v20
    v_xor_b32 v40, v40, v41
    v_mfma_f32_16x16x32_bf16 v[92:95], v[128:131], v[188:191], v[92:95]
    ds_read_b128 v[116:119], v5 offset:1216
    v_and_b32 v41, 1, v9
    v_lshlrev_b32 v41, 3, v41
    v_lshl_add_u32 v40, v40, 4, v41
    v_mfma_f32_16x16x32_bf16 v[68:71], v[132:135], v[160:163], v[68:71]
    ds_read_b128 v[120:123], v5 offset:704
    v_lshl_add_u32 v40, v20, 7, v40
    s_lshl_b32 s66, s57, 12
    s_add_u32 s66, s66, 147456
    v_mfma_f32_16x16x32_bf16 v[72:75], v[132:135], v[164:167], v[72:75]
    ds_read_b128 v[124:127], v5 offset:192
    v_add_u32 v40, s66, v40
    v_xor_b32 v41, 32, v40
    v_xor_b32 v42, 64, v40
    v_mfma_f32_16x16x32_bf16 v[76:79], v[132:135], v[168:171], v[76:79]
    ds_read_b64 v[196:197], v4 offset:704
    v_xor_b32 v43, 0x60, v40
    s_lshl_b32 s66, s62, 1
    s_add_u32 s66, s66, s64
    v_mfma_f32_16x16x32_bf16 v[80:83], v[132:135], v[172:175], v[80:83]
    ds_read_b64 v[198:199], v4 offset:712
    s_mul_i32 s66, s66, 14
    s_add_u32 s66, s66, s65
    s_mov_b32 s94, 0
    v_mfma_f32_16x16x32_bf16 v[84:87], v[132:135], v[176:179], v[84:87]
    ds_read_b64 v[200:201], v4 offset:1216
    s_movk_i32 s95, 0x3000
    s_lshl_b32 s67, s94, 1
    s_add_u32 s66, s66, s67
    v_mfma_f32_16x16x32_bf16 v[88:91], v[132:135], v[180:183], v[88:91]
    ds_read_b64 v[202:203], v4 offset:1224
    s_lshl_b32 s72, s66, 13
    s_add_u32 s72, s72, 0x400000
    s_lshl_b32 s66, s71, 1
    v_mfma_f32_16x16x32_bf16 v[92:95], v[132:135], v[184:187], v[92:95]
    ds_read_b64 v[204:205], v4 offset:1728
    s_add_u32 s66, s66, s64
    s_lshl_b32 s78, s65, 9
    s_add_u32 s78, s78, s66
    v_mfma_f32_16x16x32_bf16 v[72:75], v[136:139], v[160:163], v[72:75]
    ds_read_b64 v[206:207], v4 offset:1736
    s_lshl_b32 s78, s78, 3
    s_add_u32 s78, s78, 0xd20000
    s_lshl_b32 s66, s66, 7
    v_mfma_f32_16x16x32_bf16 v[76:79], v[136:139], v[164:167], v[76:79]
    ds_read_b64 v[208:209], v4 offset:2240
    s_lshl_b32 s67, s65, 20
    s_add_u32 s66, s66, s67
    s_add_u32 s81, s66, 0x200000
    v_mfma_f32_16x16x32_bf16 v[80:83], v[136:139], v[168:171], v[80:83]
    ds_read_b64 v[210:211], v4 offset:2248
    s_add_u32 s83, s81, 0x80000
    s_and_b32 s64, s56, 1
    s_lshl_b32 s64, s64, 2
    v_mfma_f32_16x16x32_bf16 v[84:87], v[136:139], v[172:175], v[84:87]
    ds_read_b64 v[212:213], v4 offset:2752
    v_or_b32 v44, s64, v9
    v_xor_b32 v44, v44, v1
    v_mfma_f32_16x16x32_bf16 v[88:91], v[136:139], v[176:179], v[88:91]
    ds_read_b64 v[214:215], v4 offset:2760
    s_lshl_b32 s64, s56, 10
    s_add_u32 s65, s64, 131072
    v_mfma_f32_16x16x32_bf16 v[92:95], v[136:139], v[180:183], v[92:95]
    ds_read_b64 v[216:217], v4 offset:3264
    v_lshl_add_u32 v44, v44, 4, s65
    v_lshrrev_b32 v45, 3, v1
    v_mfma_f32_16x16x32_bf16 v[76:79], v[140:143], v[160:163], v[76:79]
    ds_read_b64 v[218:219], v4 offset:3272
    v_and_b32 v46, 7, v1
    v_xor_b32 v47, v45, v46
    v_mfma_f32_16x16x32_bf16 v[80:83], v[140:143], v[164:167], v[80:83]
    ds_read_b64 v[220:221], v4 offset:3776
    v_lshlrev_b32 v45, 7, v45
    s_add_u32 s65, s64, 147456
    v_mfma_f32_16x16x32_bf16 v[84:87], v[140:143], v[168:171], v[84:87]
    ds_read_b64 v[222:223], v4 offset:3784
    v_lshl_add_u32 v45, v47, 4, v45
    v_add_u32 v45, s65, v45
    v_mfma_f32_16x16x32_bf16 v[88:91], v[140:143], v[172:175], v[88:91]
    v_lshrrev_b32 v47, 5, v1
    v_lshlrev_b32 v47, 18, v47
    v_mfma_f32_16x16x32_bf16 v[92:95], v[140:143], v[176:179], v[92:95]
    v_lshl_add_u32 v46, v46, 4, v47
    v_bfe_u32 v47, v1, 3, 2
    v_mfma_f32_16x16x32_bf16 v[80:83], v[144:147], v[160:163], v[80:83]
    v_lshl_add_u32 v46, v47, 10, v46
    s_lshr_b32 s80, s62, 3
    v_mfma_f32_16x16x32_bf16 v[84:87], v[144:147], v[164:167], v[84:87]
    s_lshl_b32 s80, s80, 9
    s_bfe_u32 s65, s62, 0x20001
    v_mfma_f32_16x16x32_bf16 v[88:91], v[144:147], v[168:171], v[88:91]
    s_lshl_b32 s65, s65, 2
    s_add_u32 s80, s80, s65
    v_mfma_f32_16x16x32_bf16 v[92:95], v[144:147], v[172:175], v[92:95]
    s_and_b32 s65, s62, 1
    s_lshl_b32 s65, s65, 7
    v_mfma_f32_16x16x32_bf16 v[84:87], v[148:151], v[160:163], v[84:87]
    s_add_u32 s80, s80, s65
    s_lshl_b32 s65, s56, 4
    v_mfma_f32_16x16x32_bf16 v[88:91], v[148:151], v[164:167], v[88:91]
    s_add_u32 s80, s80, s65
    s_lshl_b32 s80, s80, 10
    v_mfma_f32_16x16x32_bf16 v[92:95], v[148:151], v[168:171], v[92:95]
    s_lshl_b32 s65, s63, 7
    s_add_u32 s80, s80, s65
    v_mfma_f32_16x16x32_bf16 v[88:91], v[152:155], v[160:163], v[88:91]
    s_lshl_b32 s65, s56, 6
    s_add_u32 s65, s65, 140864
    v_mfma_f32_16x16x32_bf16 v[92:95], v[152:155], v[164:167], v[92:95]
    v_and_b32 v47, 0x38, v1
    v_add_u32 v47, s65, v47
    v_mfma_f32_16x16x32_bf16 v[92:95], v[156:159], v[160:163], v[92:95]
    s_lshl_b32 s79, s62, 9
    s_add_u32 s79, s79, 0xc00000
    s_waitcnt lgkmcnt(0)
    v_mfma_f32_16x16x32_bf16 v[64:67], v[192:195], v[96:99], v[64:67]
    ds_read_b64 v[128:129], v6 offset:1536
    v_mfma_f32_16x16x32_bf16 v[68:71], v[192:195], v[100:103], v[68:71]
    ds_read_b64 v[130:131], v6 offset:1024
    v_mfma_f32_16x16x32_bf16 v[72:75], v[192:195], v[104:107], v[72:75]
    ds_read_b64 v[132:133], v6 offset:512
    v_mfma_f32_16x16x32_bf16 v[76:79], v[192:195], v[108:111], v[76:79]
    ds_read_b64 v[134:135], v6 offset:0
    v_mfma_f32_16x16x32_bf16 v[80:83], v[192:195], v[112:115], v[80:83]
    s_mov_b32 s90, s72
    s_add_u32 s91, s72, 4096
    v_mfma_f32_16x16x32_bf16 v[84:87], v[192:195], v[116:119], v[84:87]
    s_cmp_eq_u32 s94, 6
    s_cselect_b32 s64, -102400, s95
    v_mfma_f32_16x16x32_bf16 v[88:91], v[192:195], v[120:123], v[88:91]
    s_add_u32 s92, s91, s64
    s_mov_b32 s72, s91
    v_mfma_f32_16x16x32_bf16 v[92:95], v[192:195], v[124:127], v[92:95]
    v_mfma_f32_16x16x32_bf16 v[68:71], v[196:199], v[96:99], v[68:71]
    v_mfma_f32_16x16x32_bf16 v[72:75], v[196:199], v[100:103], v[72:75]
    v_mfma_f32_16x16x32_bf16 v[76:79], v[196:199], v[104:107], v[76:79]
    v_mfma_f32_16x16x32_bf16 v[80:83], v[196:199], v[108:111], v[80:83]
    v_mfma_f32_16x16x32_bf16 v[84:87], v[196:199], v[112:115], v[84:87]
    s_waitcnt lgkmcnt(0)
    v_mfma_f32_16x16x32_bf16 v[88:91], v[196:199], v[116:119], v[88:91]
    v_and_b32 v136, 0xffff0000, v129
    v_lshlrev_b32 v137, 16, v129
    v_mfma_f32_16x16x32_bf16 v[92:95], v[196:199], v[120:123], v[92:95]
    v_and_b32 v138, 0xffff0000, v128
    v_lshlrev_b32 v139, 16, v128
    v_mfma_f32_16x16x32_bf16 v[72:75], v[200:203], v[96:99], v[72:75]
    v_and_b32 v140, 0xffff0000, v131
    v_lshlrev_b32 v141, 16, v131
    v_mfma_f32_16x16x32_bf16 v[76:79], v[200:203], v[100:103], v[76:79]
    v_and_b32 v142, 0xffff0000, v130
    v_lshlrev_b32 v143, 16, v130
    v_mfma_f32_16x16x32_bf16 v[80:83], v[200:203], v[104:107], v[80:83]
    v_and_b32 v144, 0xffff0000, v133
    v_lshlrev_b32 v145, 16, v133
    v_mfma_f32_16x16x32_bf16 v[84:87], v[200:203], v[108:111], v[84:87]
    v_and_b32 v146, 0xffff0000, v132
    v_lshlrev_b32 v147, 16, v132
    v_mfma_f32_16x16x32_bf16 v[88:91], v[200:203], v[112:115], v[88:91]
    v_and_b32 v148, 0xffff0000, v135
    v_lshlrev_b32 v149, 16, v135
    v_mfma_f32_16x16x32_bf16 v[92:95], v[200:203], v[116:119], v[92:95]
    v_and_b32 v150, 0xffff0000, v134
    v_lshlrev_b32 v151, 16, v134
    v_mfma_f32_16x16x32_bf16 v[76:79], v[204:207], v[96:99], v[76:79]
    v_mfma_f32_16x16x32_bf16 v[80:83], v[204:207], v[100:103], v[80:83]
    s_bitcmp1_b32 s57, 1
    s_cselect_b32 s64, 0, 16
    v_mfma_f32_16x16x32_bf16 v[84:87], v[204:207], v[104:107], v[84:87]
    s_lshl_b32 s64, s75, s64
    s_and_b32 s75, s64, 0xffff0000
    v_mfma_f32_16x16x32_bf16 v[88:91], v[204:207], v[108:111], v[88:91]
    v_mfma_f32_16x16x32_bf16 v[92:95], v[204:207], v[112:115], v[92:95]
    v_mfma_f32_16x16x32_bf16 v[80:83], v[208:211], v[96:99], v[80:83]
    v_mfma_f32_16x16x32_bf16 v[84:87], v[208:211], v[100:103], v[84:87]
    v_mfma_f32_16x16x32_bf16 v[88:91], v[208:211], v[104:107], v[88:91]
    v_mfma_f32_16x16x32_bf16 v[92:95], v[208:211], v[108:111], v[92:95]
    v_mfma_f32_16x16x32_bf16 v[84:87], v[212:215], v[96:99], v[84:87]
    v_mfma_f32_16x16x32_bf16 v[88:91], v[212:215], v[100:103], v[88:91]
    v_mfma_f32_16x16x32_bf16 v[92:95], v[212:215], v[104:107], v[92:95]
    v_mfma_f32_16x16x32_bf16 v[88:91], v[216:219], v[96:99], v[88:91]
    v_mfma_f32_16x16x32_bf16 v[92:95], v[216:219], v[100:103], v[92:95]
    v_mfma_f32_16x16x32_bf16 v[92:95], v[220:223], v[96:99], v[92:95]
    s_bitcmp1_b32 s57, 0
    s_cbranch_scc1 L_cx1
    v_fmac_f32 v64, s75, v136
    v_fmac_f32 v65, s75, v137
    v_fmac_f32 v66, s75, v138
    v_fmac_f32 v67, s75, v139
    v_fmac_f32 v68, s75, v140
    v_fmac_f32 v69, s75, v141
    v_fmac_f32 v70, s75, v142
    v_fmac_f32 v71, s75, v143
    v_fmac_f32 v72, s75, v144
    ds_write_b128 v7, v[80:83] offset:0
    ds_write_b128 v7, v[84:87] offset:1024
    ds_write_b128 v7, v[88:91] offset:2048
    ds_write_b128 v7, v[92:95] offset:3072
    v_fmac_f32 v73, s75, v145
    v_fmac_f32 v74, s75, v146
    v_fmac_f32 v75, s75, v147
    v_fmac_f32 v76, s75, v148
    v_fmac_f32 v77, s75, v149
    v_fmac_f32 v78, s75, v150
    v_fmac_f32 v79, s75, v151
    s_branch L_cx2
L_cx1:
    ds_write_b128 v7, v[64:67] offset:0
    ds_write_b128 v7, v[68:71] offset:1024
    ds_write_b128 v7, v[72:75] offset:2048
    ds_write_b128 v7, v[76:79] offset:3072
    s_nop 1
    v_fma_f32 v64, s75, v136, v80
    v_fma_f32 v65, s75, v137, v81
    v_fma_f32 v66, s75, v138, v82
    v_fma_f32 v67, s75, v139, v83
    v_fma_f32 v68, s75, v140, v84
    v_fma_f32 v69, s75, v141, v85
    v_fma_f32 v70, s75, v142, v86
    v_fma_f32 v71, s75, v143, v87
    v_fma_f32 v72, s75, v144, v88
    v_fma_f32 v73, s75, v145, v89
    v_fma_f32 v74, s75, v146, v90
    v_fma_f32 v75, s75, v147, v91
    v_fma_f32 v76, s75, v148, v92
    v_fma_f32 v77, s75, v149, v93
    v_fma_f32 v78, s75, v150, v94
    v_fma_f32 v79, s75, v151, v95
L_cx2:
    s_waitcnt lgkmcnt(0)
    s_barrier
    ds_read_b64 v[60:61], v47
    ds_read_b128 v[80:83], v8 offset:0
    ds_read_b128 v[84:87], v8 offset:1024
    ds_read_b128 v[88:91], v8 offset:2048
    ds_read_b128 v[92:95], v8 offset:3072
    buffer_load_dwordx4 v[152:155], v26, s[36:39], s90 offen offset:0 sc1
    buffer_load_dwordx4 v[156:159], v26, s[36:39], s90 offen offset:1024 sc1
    buffer_load_dwordx4 v[160:163], v26, s[36:39], s90 offen offset:2048 sc1
    buffer_load_dwordx4 v[164:167], v26, s[36:39], s90 offen offset:3072 sc1
    buffer_load_dwordx4 v[168:171], v26, s[36:39], s91 offen offset:0 sc1
    buffer_load_dwordx4 v[172:175], v26, s[36:39], s91 offen offset:1024 sc1
L_h_early:
    s_waitcnt lgkmcnt(2)
    v_pk_add_f32 v[64:65], v[64:65], v[80:81]
    v_pk_add_f32 v[66:67], v[66:67], v[82:83]
    v_pk_add_f32 v[68:69], v[68:69], v[84:85]
    v_pk_add_f32 v[70:71], v[70:71], v[86:87]
    v_cvt_pk_bf16_f32 v48, v64, v65
    v_cvt_pk_bf16_f32 v49, v66, v67
    v_cvt_pk_bf16_f32 v50, v68, v69
    v_cvt_pk_bf16_f32 v51, v70, v71
    buffer_store_dwordx4 v[48:51], v10, s[36:39], s81 offen sc1
    s_waitcnt lgkmcnt(0)
    v_pk_add_f32 v[72:73], v[72:73], v[88:89]
    v_pk_add_f32 v[74:75], v[74:75], v[90:91]
    v_pk_add_f32 v[76:77], v[76:77], v[92:93]
    v_pk_add_f32 v[78:79], v[78:79], v[94:95]
    v_cvt_pk_bf16_f32 v52, v72, v73
    v_cvt_pk_bf16_f32 v53, v74, v75
    v_cvt_pk_bf16_f32 v54, v76, v77
    v_cvt_pk_bf16_f32 v55, v78, v79
    buffer_store_dwordx4 v[52:55], v10, s[36:39], s83 offen sc1
    ds_read_b64_tr_b16 v[96:97], v36 offset:0
    ds_read_b64_tr_b16 v[98:99], v36 offset:2048
    ds_read_b64_tr_b16 v[100:101], v37 offset:0
    ds_read_b64_tr_b16 v[102:103], v37 offset:2048
    ds_read_b64_tr_b16 v[104:105], v38 offset:0
    ds_read_b64_tr_b16 v[106:107], v38 offset:2048
    ds_read_b64_tr_b16 v[108:109], v39 offset:0
    ds_read_b64_tr_b16 v[110:111], v39 offset:2048
    buffer_load_dwordx4 v[176:179], v26, s[36:39], s72 offen offset:2048 sc1
    buffer_load_dwordx4 v[180:183], v26, s[36:39], s72 offen offset:3072 sc1
    s_add_u32 s72, s72, 12288
    buffer_load_dwordx4 v[184:187], v26, s[36:39], s72 offen offset:0 sc1
    buffer_load_dwordx4 v[188:191], v26, s[36:39], s72 offen offset:1024 sc1
    buffer_load_dwordx4 v[192:195], v26, s[36:39], s72 offen offset:2048 sc1
    buffer_load_dwordx4 v[196:199], v26, s[36:39], s72 offen offset:3072 sc1
    s_add_u32 s72, s72, 4096
    s_waitcnt vmcnt(12) lgkmcnt(4)
    v_mfma_f32_16x16x32_bf16 v[64:67], v[96:99], v[152:155], 0
    ds_read_b64_tr_b16 v[112:113], v36 offset:4096
    v_mfma_f32_16x16x32_bf16 v[68:71], v[96:99], v[156:159], 0
    ds_read_b64_tr_b16 v[114:115], v36 offset:6144
    buffer_load_dwordx4 v[200:203], v26, s[36:39], s72 offen offset:0 sc1
    v_mfma_f32_16x16x32_bf16 v[72:75], v[100:103], v[152:155], 0
    ds_read_b64_tr_b16 v[116:117], v37 offset:4096
    v_mfma_f32_16x16x32_bf16 v[76:79], v[100:103], v[156:159], 0
    ds_read_b64_tr_b16 v[118:119], v37 offset:6144
    s_waitcnt lgkmcnt(4)
    v_mfma_f32_16x16x32_bf16 v[80:83], v[104:107], v[152:155], 0
    ds_read_b64_tr_b16 v[120:121], v38 offset:4096
    v_mfma_f32_16x16x32_bf16 v[84:87], v[104:107], v[156:159], 0
    ds_read_b64_tr_b16 v[122:123], v38 offset:6144
    buffer_load_dwordx4 v[204:207], v26, s[36:39], s72 offen offset:1024 sc1
    v_mfma_f32_16x16x32_bf16 v[88:91], v[108:111], v[152:155], 0
    ds_read_b64_tr_b16 v[124:125], v39 offset:4096
    v_mfma_f32_16x16x32_bf16 v[92:95], v[108:111], v[156:159], 0
    ds_read_b64_tr_b16 v[126:127], v39 offset:6144
    s_waitcnt vmcnt(12) lgkmcnt(4)
    v_mfma_f32_16x16x32_bf16 v[64:67], v[112:115], v[160:163], v[64:67]
    ds_read_b64_tr_b16 v[96:97], v36 offset:8192
    v_mfma_f32_16x16x32_bf16 v[68:71], v[112:115], v[164:167], v[68:71]
    ds_read_b64_tr_b16 v[98:99], v36 offset:10240
    buffer_load_dwordx4 v[152:155], v26, s[36:39], s72 offen offset:2048 sc1
    v_mfma_f32_16x16x32_bf16 v[72:75], v[116:119], v[160:163], v[72:75]
    ds_read_b64_tr_b16 v[100:101], v37 offset:8192
    v_mfma_f32_16x16x32_bf16 v[76:79], v[116:119], v[164:167], v[76:79]
    ds_read_b64_tr_b16 v[102:103], v37 offset:10240
    s_waitcnt lgkmcnt(4)
    v_mfma_f32_16x16x32_bf16 v[80:83], v[120:123], v[160:163], v[80:83]
    ds_read_b64_tr_b16 v[104:105], v38 offset:8192
    v_mfma_f32_16x16x32_bf16 v[84:87], v[120:123], v[164:167], v[84:87]
    ds_read_b64_tr_b16 v[106:107], v38 offset:10240
    buffer_load_dwordx4 v[156:159], v26, s[36:39], s72 offen offset:3072 sc1
    v_mfma_f32_16x16x32_bf16 v[88:91], v[124:127], v[160:163], v[88:91]
    ds_read_b64_tr_b16 v[108:109], v39 offset:8192
    s_add_u32 s72, s72, 12288
    v_mfma_f32_16x16x32_bf16 v[92:95], v[124:127], v[164:167], v[92:95]
    ds_read_b64_tr_b16 v[110:111], v39 offset:10240
    s_waitcnt vmcnt(12) lgkmcnt(4)
    v_mfma_f32_16x16x32_bf16 v[64:67], v[96:99], v[168:171], v[64:67]
    ds_read_b64_tr_b16 v[112:113], v36 offset:12288
    v_mfma_f32_16x16x32_bf16 v[68:71], v[96:99], v[172:175], v[68:71]
    ds_read_b64_tr_b16 v[114:115], v36 offset:14336
    buffer_load_dwordx4 v[160:163], v26, s[36:39], s72 offen offset:0 sc1
    v_mfma_f32_16x16x32_bf16 v[72:75], v[100:103], v[168:171], v[72:75]
    ds_read_b64_tr_b16 v[116:117], v37 offset:12288
    v_mfma_f32_16x16x32_bf16 v[76:79], v[100:103], v[172:175], v[76:79]
    ds_read_b64_tr_b16 v[118:119], v37 offset:14336
    s_waitcnt lgkmcnt(4)
    v_mfma_f32_16x16x32_bf16 v[80:83], v[104:107], v[168:171], v[80:83]
    ds_read_b64_tr_b16 v[120:121], v38 offset:12288
    v_mfma_f32_16x16x32_bf16 v[84:87], v[104:107], v[172:175], v[84:87]
    ds_read_b64_tr_b16 v[122:123], v38 offset:14336
    buffer_load_dwordx4 v[164:167], v26, s[36:39], s72 offen offset:1024 sc1
    v_mfma_f32_16x16x32_bf16 v[88:91], v[108:111], v[168:171], v[88:91]
    ds_read_b64_tr_b16 v[124:125], v39 offset:12288
    v_mfma_f32_16x16x32_bf16 v[92:95], v[108:111], v[172:175], v[92:95]
    ds_read_b64_tr_b16 v[126:127], v39 offset:14336
    s_waitcnt vmcnt(10) lgkmcnt(4)
    v_mfma_f32_16x16x32_bf16 v[64:67], v[112:115], v[176:179], v[64:67]
    buffer_load_dwordx4 v[168:171], v26, s[36:39], s72 offen offset:2048 sc1
    v_mfma_f32_16x16x32_bf16 v[68:71], v[112:115], v[180:183], v[68:71]
    buffer_store_dwordx2 v[2:3], v28, s[36:39], s78 offen sc1
    s_waitcnt lgkmcnt(0)
    s_barrier
    v_mfma_f32_16x16x32_bf16 v[72:75], v[116:119], v[176:179], v[72:75]
    ds_read_b64_tr_b16 v[96:97], v32 offset:0
    ds_read_b64_tr_b16 v[98:99], v32 offset:2048
    v_mfma_f32_16x16x32_bf16 v[76:79], v[116:119], v[180:183], v[76:79]
    ds_read_b64_tr_b16 v[100:101], v33 offset:0
    ds_read_b64_tr_b16 v[102:103], v33 offset:2048
    v_mfma_f32_16x16x32_bf16 v[80:83], v[120:123], v[176:179], v[80:83]
    ds_read_b64_tr_b16 v[104:105], v34 offset:0
    v_mfma_f32_16x16x32_bf16 v[84:87], v[120:123], v[180:183], v[84:87]
    ds_read_b64_tr_b16 v[106:107], v34 offset:2048
    buffer_load_dwordx4 v[172:175], v26, s[36:39], s72 offen offset:3072 sc1
    v_mfma_f32_16x16x32_bf16 v[88:91], v[124:127], v[176:179], v[88:91]
    ds_read_b64_tr_b16 v[108:109], v35 offset:0
    v_mfma_f32_16x16x32_bf16 v[92:95], v[124:127], v[180:183], v[92:95]
    ds_read_b64_tr_b16 v[110:111], v35 offset:2048
    s_add_u32 s72, s72, 4096
    s_waitcnt vmcnt(11) lgkmcnt(4)
    v_mfma_f32_16x16x32_bf16 v[64:67], v[96:99], v[184:187], v[64:67]
    ds_read_b64_tr_b16 v[112:113], v32 offset:4096
    v_mfma_f32_16x16x32_bf16 v[68:71], v[96:99], v[188:191], v[68:71]
    ds_read_b64_tr_b16 v[114:115], v32 offset:6144
    buffer_load_dwordx4 v[176:179], v26, s[36:39], s72 offen offset:0 sc1
    v_mfma_f32_16x16x32_bf16 v[72:75], v[100:103], v[184:187], v[72:75]
    ds_read_b64_tr_b16 v[116:117], v33 offset:4096
    v_mfma_f32_16x16x32_bf16 v[76:79], v[100:103], v[188:191], v[76:79]
    ds_read_b64_tr_b16 v[118:119], v33 offset:6144
    s_waitcnt lgkmcnt(4)
    v_mfma_f32_16x16x32_bf16 v[80:83], v[104:107], v[184:187], v[80:83]
    ds_read_b64_tr_b16 v[120:121], v34 offset:4096
    v_mfma_f32_16x16x32_bf16 v[84:87], v[104:107], v[188:191], v[84:87]
    ds_read_b64_tr_b16 v[122:123], v34 offset:6144
    buffer_load_dwordx4 v[180:183], v26, s[36:39], s72 offen offset:1024 sc1
    v_mfma_f32_16x16x32_bf16 v[88:91], v[108:111], v[184:187], v[88:91]
    ds_read_b64_tr_b16 v[124:125], v35 offset:4096
    v_mfma_f32_16x16x32_bf16 v[92:95], v[108:111], v[188:191], v[92:95]
    ds_read_b64_tr_b16 v[126:127], v35 offset:6144
    s_waitcnt vmcnt(11) lgkmcnt(4)
    v_mfma_f32_16x16x32_bf16 v[64:67], v[112:115], v[192:195], v[64:67]
    ds_read_b64_tr_b16 v[96:97], v32 offset:8192
    v_mfma_f32_16x16x32_bf16 v[68:71], v[112:115], v[196:199], v[68:71]
    ds_read_b64_tr_b16 v[98:99], v32 offset:10240
    buffer_load_dwordx4 v[184:187], v26, s[36:39], s72 offen offset:2048 sc1
    v_mfma_f32_16x16x32_bf16 v[72:75], v[116:119], v[192:195], v[72:75]
    ds_read_b64_tr_b16 v[100:101], v33 offset:8192
    v_mfma_f32_16x16x32_bf16 v[76:79], v[116:119], v[196:199], v[76:79]
    ds_read_b64_tr_b16 v[102:103], v33 offset:10240
    s_waitcnt lgkmcnt(4)
    v_mfma_f32_16x16x32_bf16 v[80:83], v[120:123], v[192:195], v[80:83]
    ds_read_b64_tr_b16 v[104:105], v34 offset:8192
    v_mfma_f32_16x16x32_bf16 v[84:87], v[120:123], v[196:199], v[84:87]
    ds_read_b64_tr_b16 v[106:107], v34 offset:10240
    buffer_load_dwordx4 v[188:191], v26, s[36:39], s72 offen offset:3072 sc1
    v_mfma_f32_16x16x32_bf16 v[88:91], v[124:127], v[192:195], v[88:91]
    ds_read_b64_tr_b16 v[108:109], v35 offset:8192
    s_add_u32 s72, s72, 12288
    v_mfma_f32_16x16x32_bf16 v[92:95], v[124:127], v[196:199], v[92:95]
    ds_read_b64_tr_b16 v[110:111], v35 offset:10240
    s_waitcnt vmcnt(11) lgkmcnt(4)
    v_mfma_f32_16x16x32_bf16 v[64:67], v[96:99], v[200:203], v[64:67]
    ds_read_b64_tr_b16 v[112:113], v32 offset:12288
    v_mfma_f32_16x16x32_bf16 v[68:71], v[96:99], v[204:207], v[68:71]
    ds_read_b64_tr_b16 v[114:115], v32 offset:14336
    buffer_load_dwordx4 v[192:195], v26, s[36:39], s72 offen offset:0 sc1
    v_mfma_f32_16x16x32_bf16 v[72:75], v[100:103], v[200:203], v[72:75]
    ds_read_b64_tr_b16 v[116:117], v33 offset:12288
    v_mfma_f32_16x16x32_bf16 v[76:79], v[100:103], v[204:207], v[76:79]
    ds_read_b64_tr_b16 v[118:119], v33 offset:14336
    s_waitcnt lgkmcnt(4)
    v_mfma_f32_16x16x32_bf16 v[80:83], v[104:107], v[200:203], v[80:83]
    ds_read_b64_tr_b16 v[120:121], v34 offset:12288
    v_mfma_f32_16x16x32_bf16 v[84:87], v[104:107], v[204:207], v[84:87]
    ds_read_b64_tr_b16 v[122:123], v34 offset:14336
    buffer_load_dwordx4 v[196:199], v26, s[36:39], s72 offen offset:1024 sc1
    v_mfma_f32_16x16x32_bf16 v[88:91], v[108:111], v[200:203], v[88:91]
    ds_read_b64_tr_b16 v[124:125], v35 offset:12288
    v_mfma_f32_16x16x32_bf16 v[92:95], v[108:111], v[204:207], v[92:95]
    ds_read_b64_tr_b16 v[126:127], v35 offset:14336
    s_waitcnt vmcnt(11) lgkmcnt(4)
    v_mfma_f32_16x16x32_bf16 v[64:67], v[112:115], v[152:155], v[64:67]
    buffer_load_dwordx4 v[200:203], v26, s[36:39], s72 offen offset:2048 sc1
    v_mfma_f32_16x16x32_bf16 v[68:71], v[112:115], v[156:159], v[68:71]
    s_waitcnt lgkmcnt(0)
    s_barrier
    v_mfma_f32_16x16x32_bf16 v[72:75], v[116:119], v[152:155], v[72:75]
    ds_read_b64_tr_b16 v[96:97], v32 offset:32768
    ds_read_b64_tr_b16 v[98:99], v32 offset:34816
    v_mfma_f32_16x16x32_bf16 v[76:79], v[116:119], v[156:159], v[76:79]
    ds_read_b64_tr_b16 v[100:101], v33 offset:32768
    ds_read_b64_tr_b16 v[102:103], v33 offset:34816
    v_mfma_f32_16x16x32_bf16 v[80:83], v[120:123], v[152:155], v[80:83]
    ds_read_b64_tr_b16 v[104:105], v34 offset:32768
    v_mfma_f32_16x16x32_bf16 v[84:87], v[120:123], v[156:159], v[84:87]
    ds_read_b64_tr_b16 v[106:107], v34 offset:34816
    buffer_load_dwordx4 v[204:207], v26, s[36:39], s72 offen offset:3072 sc1
    v_mfma_f32_16x16x32_bf16 v[88:91], v[124:127], v[152:155], v[88:91]
    ds_read_b64_tr_b16 v[108:109], v35 offset:32768
    v_mfma_f32_16x16x32_bf16 v[92:95], v[124:127], v[156:159], v[92:95]
    ds_read_b64_tr_b16 v[110:111], v35 offset:34816
    s_add_u32 s72, s72, 4096
    s_waitcnt vmcnt(11) lgkmcnt(4)
    v_mfma_f32_16x16x32_bf16 v[64:67], v[96:99], v[160:163], v[64:67]
    ds_read_b64_tr_b16 v[112:113], v32 offset:36864
    v_mfma_f32_16x16x32_bf16 v[68:71], v[96:99], v[164:167], v[68:71]
    ds_read_b64_tr_b16 v[114:115], v32 offset:38912
    buffer_load_dwordx4 v[152:155], v26, s[36:39], s72 offen offset:0 sc1
    v_mfma_f32_16x16x32_bf16 v[72:75], v[100:103], v[160:163], v[72:75]
    ds_read_b64_tr_b16 v[116:117], v33 offset:36864
    v_mfma_f32_16x16x32_bf16 v[76:79], v[100:103], v[164:167], v[76:79]
    ds_read_b64_tr_b16 v[118:119], v33 offset:38912
    s_waitcnt lgkmcnt(4)
    v_mfma_f32_16x16x32_bf16 v[80:83], v[104:107], v[160:163], v[80:83]
    ds_read_b64_tr_b16 v[120:121], v34 offset:36864
    v_mfma_f32_16x16x32_bf16 v[84:87], v[104:107], v[164:167], v[84:87]
    ds_read_b64_tr_b16 v[122:123], v34 offset:38912
    buffer_load_dwordx4 v[156:159], v26, s[36:39], s72 offen offset:1024 sc1
    v_mfma_f32_16x16x32_bf16 v[88:91], v[108:111], v[160:163], v[88:91]
    ds_read_b64_tr_b16 v[124:125], v35 offset:36864
    v_mfma_f32_16x16x32_bf16 v[92:95], v[108:111], v[164:167], v[92:95]
    ds_read_b64_tr_b16 v[126:127], v35 offset:38912
    s_waitcnt vmcnt(10) lgkmcnt(4)
    v_mfma_f32_16x16x32_bf16 v[64:67], v[112:115], v[168:171], v[64:67]
    ds_read_b64_tr_b16 v[96:97], v32 offset:40960
    v_mfma_f32_16x16x32_bf16 v[68:71], v[112:115], v[172:175], v[68:71]
    ds_read_b64_tr_b16 v[98:99], v32 offset:43008
    buffer_load_dwordx4 v[160:163], v26, s[36:39], s72 offen offset:2048 sc1
    v_mfma_f32_16x16x32_bf16 v[72:75], v[116:119], v[168:171], v[72:75]
    ds_read_b64_tr_b16 v[100:101], v33 offset:40960
    v_mfma_f32_16x16x32_bf16 v[76:79], v[116:119], v[172:175], v[76:79]
    ds_read_b64_tr_b16 v[102:103], v33 offset:43008
    s_waitcnt lgkmcnt(4)
    v_mfma_f32_16x16x32_bf16 v[80:83], v[120:123], v[168:171], v[80:83]
    ds_read_b64_tr_b16 v[104:105], v34 offset:40960
    v_mfma_f32_16x16x32_bf16 v[84:87], v[120:123], v[172:175], v[84:87]
    ds_read_b64_tr_b16 v[106:107], v34 offset:43008
    buffer_load_dwordx4 v[164:167], v26, s[36:39], s72 offen offset:3072 sc1
    v_mfma_f32_16x16x32_bf16 v[88:91], v[124:127], v[168:171], v[88:91]
    ds_read_b64_tr_b16 v[108:109], v35 offset:40960
    s_add_u32 s72, s72, 12288
    v_mfma_f32_16x16x32_bf16 v[92:95], v[124:127], v[172:175], v[92:95]
    ds_read_b64_tr_b16 v[110:111], v35 offset:43008
    s_waitcnt vmcnt(10) lgkmcnt(4)
    v_mfma_f32_16x16x32_bf16 v[64:67], v[96:99], v[176:179], v[64:67]
    buffer_load_dwordx4 v[248:251], v46, s[40:43], s80 offen
    ds_read_b64_tr_b16 v[112:113], v32 offset:45056
    v_mfma_f32_16x16x32_bf16 v[68:71], v[96:99], v[180:183], v[68:71]
    ds_read_b64_tr_b16 v[114:115], v32 offset:47104
    buffer_load_dwordx4 v[168:171], v26, s[36:39], s72 offen offset:0 sc1
    v_mfma_f32_16x16x32_bf16 v[72:75], v[100:103], v[176:179], v[72:75]
    ds_read_b64_tr_b16 v[116:117], v33 offset:45056
    v_mfma_f32_16x16x32_bf16 v[76:79], v[100:103], v[180:183], v[76:79]
    ds_read_b64_tr_b16 v[118:119], v33 offset:47104
    s_waitcnt lgkmcnt(4)
    v_mfma_f32_16x16x32_bf16 v[80:83], v[104:107], v[176:179], v[80:83]
    ds_read_b64_tr_b16 v[120:121], v34 offset:45056
    v_mfma_f32_16x16x32_bf16 v[84:87], v[104:107], v[180:183], v[84:87]
    ds_read_b64_tr_b16 v[122:123], v34 offset:47104
    buffer_load_dwordx4 v[172:175], v26, s[36:39], s72 offen offset:1024 sc1
    v_mfma_f32_16x16x32_bf16 v[88:91], v[108:111], v[176:179], v[88:91]
    ds_read_b64_tr_b16 v[124:125], v35 offset:45056
    v_mfma_f32_16x16x32_bf16 v[92:95], v[108:111], v[180:183], v[92:95]
    ds_read_b64_tr_b16 v[126:127], v35 offset:47104
    s_waitcnt vmcnt(11) lgkmcnt(4)
    v_mfma_f32_16x16x32_bf16 v[64:67], v[112:115], v[184:187], v[64:67]
    buffer_load_dwordx4 v[176:179], v26, s[36:39], s72 offen offset:2048 sc1
    v_mfma_f32_16x16x32_bf16 v[68:71], v[112:115], v[188:191], v[68:71]
    s_waitcnt lgkmcnt(0)
    s_barrier
    v_mfma_f32_16x16x32_bf16 v[72:75], v[116:119], v[184:187], v[72:75]
    ds_read_b64_tr_b16 v[96:97], v36 offset:32768
    ds_read_b64_tr_b16 v[98:99], v36 offset:34816
    v_mfma_f32_16x16x32_bf16 v[76:79], v[116:119], v[188:191], v[76:79]
    ds_read_b64_tr_b16 v[100:101], v37 offset:32768
    ds_read_b64_tr_b16 v[102:103], v37 offset:34816
    v_mfma_f32_16x16x32_bf16 v[80:83], v[120:123], v[184:187], v[80:83]
    ds_read_b64_tr_b16 v[104:105], v38 offset:32768
    v_mfma_f32_16x16x32_bf16 v[84:87], v[120:123], v[188:191], v[84:87]
    ds_read_b64_tr_b16 v[106:107], v38 offset:34816
    buffer_load_dwordx4 v[180:183], v26, s[36:39], s72 offen offset:3072 sc1
    v_mfma_f32_16x16x32_bf16 v[88:91], v[124:127], v[184:187], v[88:91]
    ds_read_b64_tr_b16 v[108:109], v39 offset:32768
    v_mfma_f32_16x16x32_bf16 v[92:95], v[124:127], v[188:191], v[92:95]
    ds_read_b64_tr_b16 v[110:111], v39 offset:34816
    s_add_u32 s72, s72, 4096
    s_waitcnt vmcnt(11) lgkmcnt(4)
    v_mfma_f32_16x16x32_bf16 v[64:67], v[96:99], v[192:195], v[64:67]
    ds_read_b64_tr_b16 v[112:113], v36 offset:36864
    v_mfma_f32_16x16x32_bf16 v[68:71], v[96:99], v[196:199], v[68:71]
    ds_read_b64_tr_b16 v[114:115], v36 offset:38912
    buffer_load_dwordx4 v[184:187], v26, s[36:39], s72 offen offset:0 sc1
    v_mfma_f32_16x16x32_bf16 v[72:75], v[100:103], v[192:195], v[72:75]
    ds_read_b64_tr_b16 v[116:117], v37 offset:36864
    v_mfma_f32_16x16x32_bf16 v[76:79], v[100:103], v[196:199], v[76:79]
    ds_read_b64_tr_b16 v[118:119], v37 offset:38912
    s_waitcnt lgkmcnt(4)
    v_mfma_f32_16x16x32_bf16 v[80:83], v[104:107], v[192:195], v[80:83]
    ds_read_b64_tr_b16 v[120:121], v38 offset:36864
    v_mfma_f32_16x16x32_bf16 v[84:87], v[104:107], v[196:199], v[84:87]
    ds_read_b64_tr_b16 v[122:123], v38 offset:38912
    buffer_load_dwordx4 v[188:191], v26, s[36:39], s72 offen offset:1024 sc1
    v_mfma_f32_16x16x32_bf16 v[88:91], v[108:111], v[192:195], v[88:91]
    ds_read_b64_tr_b16 v[124:125], v39 offset:36864
    v_mfma_f32_16x16x32_bf16 v[92:95], v[108:111], v[196:199], v[92:95]
    ds_read_b64_tr_b16 v[126:127], v39 offset:38912
    s_waitcnt vmcnt(11) lgkmcnt(4)
    v_mfma_f32_16x16x32_bf16 v[64:67], v[112:115], v[200:203], v[64:67]
    ds_read_b64_tr_b16 v[96:97], v36 offset:40960
    v_mfma_f32_16x16x32_bf16 v[68:71], v[112:115], v[204:207], v[68:71]
    ds_read_b64_tr_b16 v[98:99], v36 offset:43008
    buffer_load_dwordx4 v[192:195], v26, s[36:39], s72 offen offset:2048 sc1
    v_mfma_f32_16x16x32_bf16 v[72:75], v[116:119], v[200:203], v[72:75]
    ds_read_b64_tr_b16 v[100:101], v37 offset:40960
    v_mfma_f32_16x16x32_bf16 v[76:79], v[116:119], v[204:207], v[76:79]
    ds_read_b64_tr_b16 v[102:103], v37 offset:43008
    s_waitcnt lgkmcnt(4)
    v_mfma_f32_16x16x32_bf16 v[80:83], v[120:123], v[200:203], v[80:83]
    ds_read_b64_tr_b16 v[104:105], v38 offset:40960
    v_mfma_f32_16x16x32_bf16 v[84:87], v[120:123], v[204:207], v[84:87]
    ds_read_b64_tr_b16 v[106:107], v38 offset:43008
    buffer_load_dwordx4 v[196:199], v26, s[36:39], s72 offen offset:3072 sc1
    v_mfma_f32_16x16x32_bf16 v[88:91], v[124:127], v[200:203], v[88:91]
    ds_read_b64_tr_b16 v[108:109], v39 offset:40960
    s_add_u32 s72, s72, 12288
    v_mfma_f32_16x16x32_bf16 v[92:95], v[124:127], v[204:207], v[92:95]
    ds_read_b64_tr_b16 v[110:111], v39 offset:43008
    s_waitcnt vmcnt(11) lgkmcnt(4)
    v_mfma_f32_16x16x32_bf16 v[64:67], v[96:99], v[152:155], v[64:67]
    ds_read_b64_tr_b16 v[112:113], v36 offset:45056
    v_mfma_f32_16x16x32_bf16 v[68:71], v[96:99], v[156:159], v[68:71]
    ds_read_b64_tr_b16 v[114:115], v36 offset:47104
    buffer_load_dwordx4 v[200:203], v26, s[36:39], s72 offen offset:0 sc1
    v_mfma_f32_16x16x32_bf16 v[72:75], v[100:103], v[152:155], v[72:75]
    ds_read_b64_tr_b16 v[116:117], v37 offset:45056
    v_mfma_f32_16x16x32_bf16 v[76:79], v[100:103], v[156:159], v[76:79]
    ds_read_b64_tr_b16 v[118:119], v37 offset:47104
    s_waitcnt lgkmcnt(4)
    v_mfma_f32_16x16x32_bf16 v[80:83], v[104:107], v[152:155], v[80:83]
    ds_read_b64_tr_b16 v[120:121], v38 offset:45056
    v_mfma_f32_16x16x32_bf16 v[84:87], v[104:107], v[156:159], v[84:87]
    ds_read_b64_tr_b16 v[122:123], v38 offset:47104
    buffer_load_dwordx4 v[204:207], v26, s[36:39], s72 offen offset:1024 sc1
    v_mfma_f32_16x16x32_bf16 v[88:91], v[108:111], v[152:155], v[88:91]
    ds_read_b64_tr_b16 v[124:125], v39 offset:45056
    v_mfma_f32_16x16x32_bf16 v[92:95], v[108:111], v[156:159], v[92:95]
    ds_read_b64_tr_b16 v[126:127], v39 offset:47104
    s_waitcnt vmcnt(11) lgkmcnt(4)
    v_mfma_f32_16x16x32_bf16 v[64:67], v[112:115], v[160:163], v[64:67]
    ds_read_b64_tr_b16 v[96:97], v36 offset:0
    v_mfma_f32_16x16x32_bf16 v[68:71], v[112:115], v[164:167], v[68:71]
    ds_read_b64_tr_b16 v[98:99], v36 offset:2048
    buffer_load_dwordx4 v[152:155], v26, s[36:39], s72 offen offset:2048 sc1
    v_mfma_f32_16x16x32_bf16 v[72:75], v[116:119], v[160:163], v[72:75]
    ds_read_b64_tr_b16 v[100:101], v37 offset:0
    v_mfma_f32_16x16x32_bf16 v[76:79], v[116:119], v[164:167], v[76:79]
    ds_read_b64_tr_b16 v[102:103], v37 offset:2048
    s_waitcnt lgkmcnt(4)
    v_mfma_f32_16x16x32_bf16 v[80:83], v[120:123], v[160:163], v[80:83]
    ds_read_b64_tr_b16 v[104:105], v38 offset:0
    v_mfma_f32_16x16x32_bf16 v[84:87], v[120:123], v[164:167], v[84:87]
    ds_read_b64_tr_b16 v[106:107], v38 offset:2048
    buffer_load_dwordx4 v[156:159], v26, s[36:39], s72 offen offset:3072 sc1
    v_mfma_f32_16x16x32_bf16 v[88:91], v[124:127], v[160:163], v[88:91]
    ds_read_b64_tr_b16 v[108:109], v39 offset:0
    s_add_u32 s72, s72, 4096
    v_mfma_f32_16x16x32_bf16 v[92:95], v[124:127], v[164:167], v[92:95]
    ds_read_b64_tr_b16 v[110:111], v39 offset:2048
    s_waitcnt vmcnt(10) lgkmcnt(4)
    v_mfma_f32_16x16x32_bf16 v[64:67], v[96:99], v[168:171], v[64:67]
    ds_read_b64_tr_b16 v[112:113], v36 offset:4096
    v_mfma_f32_16x16x32_bf16 v[68:71], v[96:99], v[172:175], v[68:71]
    ds_read_b64_tr_b16 v[114:115], v36 offset:6144
    buffer_load_dwordx4 v[160:163], v26, s[36:39], s72 offen offset:0 sc1
    v_mfma_f32_16x16x32_bf16 v[72:75], v[100:103], v[168:171], v[72:75]
    ds_read_b64_tr_b16 v[116:117], v37 offset:4096
    v_mul_f32 v60, v60, v61
    v_mfma_f32_16x16x32_bf16 v[76:79], v[100:103], v[172:175], v[76:79]
    ds_read_b64_tr_b16 v[118:119], v37 offset:6144
    v_lshlrev_b32 v232, 16, v248
    s_waitcnt lgkmcnt(4)
    v_mfma_f32_16x16x32_bf16 v[80:83], v[104:107], v[168:171], v[80:83]
    ds_read_b64_tr_b16 v[120:121], v38 offset:4096
    v_and_b32 v233, 0xffff0000, v248
    v_mfma_f32_16x16x32_bf16 v[84:87], v[104:107], v[172:175], v[84:87]
    ds_read_b64_tr_b16 v[122:123], v38 offset:6144
    buffer_load_dwordx4 v[164:167], v26, s[36:39], s72 offen offset:1024 sc1
    v_mfma_f32_16x16x32_bf16 v[88:91], v[108:111], v[168:171], v[88:91]
    ds_read_b64_tr_b16 v[124:125], v39 offset:4096
    v_mfma_f32_16x16x32_bf16 v[92:95], v[108:111], v[172:175], v[92:95]
    ds_read_b64_tr_b16 v[126:127], v39 offset:6144
    v_lshlrev_b32 v234, 16, v249
    s_waitcnt vmcnt(10) lgkmcnt(4)
    v_mfma_f32_16x16x32_bf16 v[64:67], v[112:115], v[176:179], v[64:67]
    ds_read_b64_tr_b16 v[96:97], v36 offset:8192
    v_mfma_f32_16x16x32_bf16 v[68:71], v[112:115], v[180:183], v[68:71]
    ds_read_b64_tr_b16 v[98:99], v36 offset:10240
    buffer_load_dwordx4 v[168:171], v26, s[36:39], s72 offen offset:2048 sc1
    v_mfma_f32_16x16x32_bf16 v[72:75], v[116:119], v[176:179], v[72:75]
    ds_read_b64_tr_b16 v[100:101], v37 offset:8192
    v_and_b32 v235, 0xffff0000, v249
    v_mfma_f32_16x16x32_bf16 v[76:79], v[116:119], v[180:183], v[76:79]
    ds_read_b64_tr_b16 v[102:103], v37 offset:10240
    v_lshlrev_b32 v236, 16, v250
    s_waitcnt lgkmcnt(4)
    v_mfma_f32_16x16x32_bf16 v[80:83], v[120:123], v[176:179], v[80:83]
    ds_read_b64_tr_b16 v[104:105], v38 offset:8192
    v_and_b32 v237, 0xffff0000, v250
    v_mfma_f32_16x16x32_bf16 v[84:87], v[120:123], v[180:183], v[84:87]
    ds_read_b64_tr_b16 v[106:107], v38 offset:10240
    buffer_load_dwordx4 v[172:175], v26, s[36:39], s72 offen offset:3072 sc1
    v_mfma_f32_16x16x32_bf16 v[88:91], v[124:127], v[176:179], v[88:91]
    ds_read_b64_tr_b16 v[108:109], v39 offset:8192
    s_add_u32 s72, s72, 12288
    v_mfma_f32_16x16x32_bf16 v[92:95], v[124:127], v[180:183], v[92:95]
    ds_read_b64_tr_b16 v[110:111], v39 offset:10240
    v_lshlrev_b32 v238, 16, v251
    s_waitcnt vmcnt(10) lgkmcnt(4)
    v_mfma_f32_16x16x32_bf16 v[64:67], v[96:99], v[184:187], v[64:67]
    ds_read_b64_tr_b16 v[112:113], v36 offset:12288
    v_mfma_f32_16x16x32_bf16 v[68:71], v[96:99], v[188:191], v[68:71]
    ds_read_b64_tr_b16 v[114:115], v36 offset:14336
    buffer_load_dwordx4 v[176:179], v26, s[36:39], s72 offen offset:0 sc1
    v_mfma_f32_16x16x32_bf16 v[72:75], v[100:103], v[184:187], v[72:75]
    ds_read_b64_tr_b16 v[116:117], v37 offset:12288
    v_and_b32 v239, 0xffff0000, v251
    v_mfma_f32_16x16x32_bf16 v[76:79], v[100:103], v[188:191], v[76:79]
    ds_read_b64_tr_b16 v[118:119], v37 offset:14336
    v_fma_f32 v240, v232, v61, -v60
    s_waitcnt lgkmcnt(4)
    v_mfma_f32_16x16x32_bf16 v[80:83], v[104:107], v[184:187], v[80:83]
    ds_read_b64_tr_b16 v[120:121], v38 offset:12288
    v_fma_f32 v241, v233, v61, -v60
    v_mfma_f32_16x16x32_bf16 v[84:87], v[104:107], v[188:191], v[84:87]
    ds_read_b64_tr_b16 v[122:123], v38 offset:14336
    buffer_load_dwordx4 v[180:183], v26, s[36:39], s72 offen offset:1024 sc1
    v_mfma_f32_16x16x32_bf16 v[88:91], v[108:111], v[184:187], v[88:91]
    ds_read_b64_tr_b16 v[124:125], v39 offset:12288
    v_mfma_f32_16x16x32_bf16 v[92:95], v[108:111], v[188:191], v[92:95]
    ds_read_b64_tr_b16 v[126:127], v39 offset:14336
    v_fma_f32 v242, v234, v61, -v60
    s_waitcnt vmcnt(10) lgkmcnt(4)
    v_mfma_f32_16x16x32_bf16 v[64:67], v[112:115], v[192:195], v[64:67]
    ds_read_b64_tr_b16 v[96:97], v32 offset:0
    v_mfma_f32_16x16x32_bf16 v[68:71], v[112:115], v[196:199], v[68:71]
    ds_read_b64_tr_b16 v[98:99], v32 offset:2048
    buffer_load_dwordx4 v[184:187], v26, s[36:39], s72 offen offset:2048 sc1
    v_mfma_f32_16x16x32_bf16 v[72:75], v[116:119], v[192:195], v[72:75]
    ds_read_b64_tr_b16 v[100:101], v33 offset:0
    v_fma_f32 v243, v235, v61, -v60
    v_mfma_f32_16x16x32_bf16 v[76:79], v[116:119], v[196:199], v[76:79]
    ds_read_b64_tr_b16 v[102:103], v33 offset:2048
    v_fma_f32 v244, v236, v61, -v60
    s_waitcnt lgkmcnt(4)
    v_mfma_f32_16x16x32_bf16 v[80:83], v[120:123], v[192:195], v[80:83]
    ds_read_b64_tr_b16 v[104:105], v34 offset:0
    v_fma_f32 v245, v237, v61, -v60
    v_mfma_f32_16x16x32_bf16 v[84:87], v[120:123], v[196:199], v[84:87]
    ds_read_b64_tr_b16 v[106:107], v34 offset:2048
    buffer_load_dwordx4 v[188:191], v26, s[36:39], s72 offen offset:3072 sc1
    v_mfma_f32_16x16x32_bf16 v[88:91], v[124:127], v[192:195], v[88:91]
    ds_read_b64_tr_b16 v[108:109], v35 offset:0
    s_add_u32 s72, s72, 4096
    v_mfma_f32_16x16x32_bf16 v[92:95], v[124:127], v[196:199], v[92:95]
    ds_read_b64_tr_b16 v[110:111], v35 offset:2048
    v_fma_f32 v246, v238, v61, -v60
    s_waitcnt vmcnt(10) lgkmcnt(4)
    v_mfma_f32_16x16x32_bf16 v[64:67], v[96:99], v[200:203], v[64:67]
    ds_read_b64_tr_b16 v[112:113], v32 offset:4096
    v_mfma_f32_16x16x32_bf16 v[68:71], v[96:99], v[204:207], v[68:71]
    ds_read_b64_tr_b16 v[114:115], v32 offset:6144
    buffer_load_dwordx4 v[192:195], v26, s[36:39], s72 offen offset:0 sc1
    v_mfma_f32_16x16x32_bf16 v[72:75], v[100:103], v[200:203], v[72:75]
    ds_read_b64_tr_b16 v[116:117], v33 offset:4096
    v_fma_f32 v247, v239, v61, -v60
    v_mfma_f32_16x16x32_bf16 v[76:79], v[100:103], v[204:207], v[76:79]
    ds_read_b64_tr_b16 v[118:119], v33 offset:6144
    s_waitcnt lgkmcnt(4)
    v_mfma_f32_16x16x32_bf16 v[80:83], v[104:107], v[200:203], v[80:83]
    ds_read_b64_tr_b16 v[120:121], v34 offset:4096
    v_mfma_f32_16x16x32_bf16 v[84:87], v[104:107], v[204:207], v[84:87]
    ds_read_b64_tr_b16 v[122:123], v34 offset:6144
    buffer_load_dwordx4 v[196:199], v26, s[36:39], s72 offen offset:1024 sc1
    v_mfma_f32_16x16x32_bf16 v[88:91], v[108:111], v[200:203], v[88:91]
    ds_read_b64_tr_b16 v[124:125], v35 offset:4096
    v_mfma_f32_16x16x32_bf16 v[92:95], v[108:111], v[204:207], v[92:95]
    ds_read_b64_tr_b16 v[126:127], v35 offset:6144
    s_waitcnt vmcnt(10) lgkmcnt(4)
    v_mfma_f32_16x16x32_bf16 v[64:67], v[112:115], v[152:155], v[64:67]
    ds_read_b64_tr_b16 v[96:97], v32 offset:8192
    v_mfma_f32_16x16x32_bf16 v[68:71], v[112:115], v[156:159], v[68:71]
    ds_read_b64_tr_b16 v[98:99], v32 offset:10240
    buffer_load_dwordx4 v[200:203], v26, s[36:39], s72 offen offset:2048 sc1
    v_mfma_f32_16x16x32_bf16 v[72:75], v[116:119], v[152:155], v[72:75]
    ds_read_b64_tr_b16 v[100:101], v33 offset:8192
    v_mfma_f32_16x16x32_bf16 v[76:79], v[116:119], v[156:159], v[76:79]
    ds_read_b64_tr_b16 v[102:103], v33 offset:10240
    s_waitcnt lgkmcnt(4)
    v_mfma_f32_16x16x32_bf16 v[80:83], v[120:123], v[152:155], v[80:83]
    ds_read_b64_tr_b16 v[104:105], v34 offset:8192
    v_mfma_f32_16x16x32_bf16 v[84:87], v[120:123], v[156:159], v[84:87]
    ds_read_b64_tr_b16 v[106:107], v34 offset:10240
    buffer_load_dwordx4 v[204:207], v26, s[36:39], s72 offen offset:3072 sc1
    v_mfma_f32_16x16x32_bf16 v[88:91], v[124:127], v[152:155], v[88:91]
    ds_read_b64_tr_b16 v[108:109], v35 offset:8192
    v_mfma_f32_16x16x32_bf16 v[92:95], v[124:127], v[156:159], v[92:95]
    ds_read_b64_tr_b16 v[110:111], v35 offset:10240
    s_waitcnt vmcnt(10) lgkmcnt(4)
    v_mfma_f32_16x16x32_bf16 v[64:67], v[96:99], v[160:163], v[64:67]
    ds_read_b64_tr_b16 v[112:113], v32 offset:12288
    v_mfma_f32_16x16x32_bf16 v[68:71], v[96:99], v[164:167], v[68:71]
    ds_read_b64_tr_b16 v[114:115], v32 offset:14336
    v_mfma_f32_16x16x32_bf16 v[72:75], v[100:103], v[160:163], v[72:75]
    ds_read_b64_tr_b16 v[116:117], v33 offset:12288
    v_mfma_f32_16x16x32_bf16 v[76:79], v[100:103], v[164:167], v[76:79]
    ds_read_b64_tr_b16 v[118:119], v33 offset:14336
    s_waitcnt lgkmcnt(4)
    v_mfma_f32_16x16x32_bf16 v[80:83], v[104:107], v[160:163], v[80:83]
    ds_read_b64_tr_b16 v[120:121], v34 offset:12288
    v_mfma_f32_16x16x32_bf16 v[84:87], v[104:107], v[164:167], v[84:87]
    ds_read_b64_tr_b16 v[122:123], v34 offset:14336
    v_mfma_f32_16x16x32_bf16 v[88:91], v[108:111], v[160:163], v[88:91]
    ds_read_b64_tr_b16 v[124:125], v35 offset:12288
    v_mfma_f32_16x16x32_bf16 v[92:95], v[108:111], v[164:167], v[92:95]
    ds_read_b64_tr_b16 v[126:127], v35 offset:14336
    s_waitcnt vmcnt(8) lgkmcnt(4)
    v_mfma_f32_16x16x32_bf16 v[64:67], v[112:115], v[168:171], v[64:67]
    v_mfma_f32_16x16x32_bf16 v[68:71], v[112:115], v[172:175], v[68:71]
    s_waitcnt lgkmcnt(0)
    s_barrier
    v_mfma_f32_16x16x32_bf16 v[72:75], v[116:119], v[168:171], v[72:75]
    ds_read_b64_tr_b16 v[96:97], v32 offset:32768
    ds_read_b64_tr_b16 v[98:99], v32 offset:34816
    v_mfma_f32_16x16x32_bf16 v[76:79], v[116:119], v[172:175], v[76:79]
    ds_read_b64_tr_b16 v[100:101], v33 offset:32768
    ds_read_b64_tr_b16 v[102:103], v33 offset:34816
    v_mfma_f32_16x16x32_bf16 v[80:83], v[120:123], v[168:171], v[80:83]
    ds_read_b64_tr_b16 v[104:105], v34 offset:32768
    v_mfma_f32_16x16x32_bf16 v[84:87], v[120:123], v[172:175], v[84:87]
    ds_read_b64_tr_b16 v[106:107], v34 offset:34816
    v_mfma_f32_16x16x32_bf16 v[88:91], v[124:127], v[168:171], v[88:91]
    ds_read_b64_tr_b16 v[108:109], v35 offset:32768
    v_mfma_f32_16x16x32_bf16 v[92:95], v[124:127], v[172:175], v[92:95]
    ds_read_b64_tr_b16 v[110:111], v35 offset:34816
    s_waitcnt vmcnt(6) lgkmcnt(4)
    v_mfma_f32_16x16x32_bf16 v[64:67], v[96:99], v[176:179], v[64:67]
    ds_read_b64_tr_b16 v[112:113], v32 offset:36864
    v_mfma_f32_16x16x32_bf16 v[68:71], v[96:99], v[180:183], v[68:71]
    ds_read_b64_tr_b16 v[114:115], v32 offset:38912
    v_mfma_f32_16x16x32_bf16 v[72:75], v[100:103], v[176:179], v[72:75]
    ds_read_b64_tr_b16 v[116:117], v33 offset:36864
    v_mfma_f32_16x16x32_bf16 v[76:79], v[100:103], v[180:183], v[76:79]
    ds_read_b64_tr_b16 v[118:119], v33 offset:38912
    s_waitcnt lgkmcnt(4)
    v_mfma_f32_16x16x32_bf16 v[80:83], v[104:107], v[176:179], v[80:83]
    ds_read_b64_tr_b16 v[120:121], v34 offset:36864
    v_mfma_f32_16x16x32_bf16 v[84:87], v[104:107], v[180:183], v[84:87]
    ds_read_b64_tr_b16 v[122:123], v34 offset:38912
    v_mfma_f32_16x16x32_bf16 v[88:91], v[108:111], v[176:179], v[88:91]
    ds_read_b64_tr_b16 v[124:125], v35 offset:36864
    v_mfma_f32_16x16x32_bf16 v[92:95], v[108:111], v[180:183], v[92:95]
    ds_read_b64_tr_b16 v[126:127], v35 offset:38912
    s_waitcnt vmcnt(4) lgkmcnt(4)
    v_mfma_f32_16x16x32_bf16 v[64:67], v[112:115], v[184:187], v[64:67]
    ds_read_b64_tr_b16 v[96:97], v32 offset:40960
    v_mfma_f32_16x16x32_bf16 v[68:71], v[112:115], v[188:191], v[68:71]
    ds_read_b64_tr_b16 v[98:99], v32 offset:43008
    v_mfma_f32_16x16x32_bf16 v[72:75], v[116:119], v[184:187], v[72:75]
    ds_read_b64_tr_b16 v[100:101], v33 offset:40960
    v_mfma_f32_16x16x32_bf16 v[76:79], v[116:119], v[188:191], v[76:79]
    ds_read_b64_tr_b16 v[102:103], v33 offset:43008
    s_waitcnt lgkmcnt(4)
    v_mfma_f32_16x16x32_bf16 v[80:83], v[120:123], v[184:187], v[80:83]
    ds_read_b64_tr_b16 v[104:105], v34 offset:40960
    v_mfma_f32_16x16x32_bf16 v[84:87], v[120:123], v[188:191], v[84:87]
    ds_read_b64_tr_b16 v[106:107], v34 offset:43008
    v_mfma_f32_16x16x32_bf16 v[88:91], v[124:127], v[184:187], v[88:91]
    ds_read_b64_tr_b16 v[108:109], v35 offset:40960
    v_mfma_f32_16x16x32_bf16 v[92:95], v[124:127], v[188:191], v[92:95]
    ds_read_b64_tr_b16 v[110:111], v35 offset:43008
    s_waitcnt vmcnt(2) lgkmcnt(4)
    v_mfma_f32_16x16x32_bf16 v[64:67], v[96:99], v[192:195], v[64:67]
    ds_read_b64_tr_b16 v[112:113], v32 offset:45056
    v_mfma_f32_16x16x32_bf16 v[68:71], v[96:99], v[196:199], v[68:71]
    ds_read_b64_tr_b16 v[114:115], v32 offset:47104
    v_mfma_f32_16x16x32_bf16 v[72:75], v[100:103], v[192:195], v[72:75]
    ds_read_b64_tr_b16 v[116:117], v33 offset:45056
    v_mfma_f32_16x16x32_bf16 v[76:79], v[100:103], v[196:199], v[76:79]
    ds_read_b64_tr_b16 v[118:119], v33 offset:47104
    s_waitcnt lgkmcnt(4)
    v_mfma_f32_16x16x32_bf16 v[80:83], v[104:107], v[192:195], v[80:83]
    ds_read_b64_tr_b16 v[120:121], v34 offset:45056
    v_mfma_f32_16x16x32_bf16 v[84:87], v[104:107], v[196:199], v[84:87]
    ds_read_b64_tr_b16 v[122:123], v34 offset:47104
    v_mfma_f32_16x16x32_bf16 v[88:91], v[108:111], v[192:195], v[88:91]
    ds_read_b64_tr_b16 v[124:125], v35 offset:45056
    v_mfma_f32_16x16x32_bf16 v[92:95], v[108:111], v[196:199], v[92:95]
    ds_read_b64_tr_b16 v[126:127], v35 offset:47104
    s_waitcnt vmcnt(0) lgkmcnt(4)
    v_mfma_f32_16x16x32_bf16 v[64:67], v[112:115], v[200:203], v[64:67]
    v_mfma_f32_16x16x32_bf16 v[68:71], v[112:115], v[204:207], v[68:71]
    v_mfma_f32_16x16x32_bf16 v[72:75], v[116:119], v[200:203], v[72:75]
    v_mfma_f32_16x16x32_bf16 v[76:79], v[116:119], v[204:207], v[76:79]
    s_waitcnt lgkmcnt(0)
    v_mfma_f32_16x16x32_bf16 v[80:83], v[120:123], v[200:203], v[80:83]
    v_mfma_f32_16x16x32_bf16 v[84:87], v[120:123], v[204:207], v[84:87]
    v_mfma_f32_16x16x32_bf16 v[88:91], v[124:127], v[200:203], v[88:91]
    v_mfma_f32_16x16x32_bf16 v[92:95], v[124:127], v[204:207], v[92:95]
    v_cvt_pk_bf16_f32 v96, v64, v65
    v_cvt_pk_bf16_f32 v97, v66, v67
    ds_write_b64 v40, v[96:97] offset:0
    v_cvt_pk_bf16_f32 v98, v68, v69
    v_cvt_pk_bf16_f32 v99, v70, v71
    ds_write_b64 v40, v[98:99] offset:2048
    v_cvt_pk_bf16_f32 v100, v72, v73
    v_cvt_pk_bf16_f32 v101, v74, v75
    ds_write_b64 v41, v[100:101] offset:0
    v_cvt_pk_bf16_f32 v102, v76, v77
    v_cvt_pk_bf16_f32 v103, v78, v79
    ds_write_b64 v41, v[102:103] offset:2048
    v_cvt_pk_bf16_f32 v104, v80, v81
    v_cvt_pk_bf16_f32 v105, v82, v83
    ds_write_b64 v42, v[104:105] offset:0
    v_cvt_pk_bf16_f32 v106, v84, v85
    v_cvt_pk_bf16_f32 v107, v86, v87
    ds_write_b64 v42, v[106:107] offset:2048
    v_cvt_pk_bf16_f32 v108, v88, v89
    v_cvt_pk_bf16_f32 v109, v90, v91
    ds_write_b64 v43, v[108:109] offset:0
    v_cvt_pk_bf16_f32 v110, v92, v93
    v_cvt_pk_bf16_f32 v111, v94, v95
    ds_write_b64 v43, v[110:111] offset:2048
    s_waitcnt vmcnt(0) lgkmcnt(0)
    s_barrier
    ds_read_b128 v[64:67], v44
    ds_read_b128 v[104:107], v45 offset:0
    ds_read_b128 v[108:111], v45 offset:8192
    s_waitcnt lgkmcnt(2)
    v_lshlrev_b32 v80, 16, v64
    v_and_b32 v81, 0xffff0000, v64
    v_lshlrev_b32 v82, 16, v65
    v_and_b32 v83, 0xffff0000, v65
    v_lshlrev_b32 v84, 16, v66
    v_and_b32 v85, 0xffff0000, v66
    v_lshlrev_b32 v86, 16, v67
    v_and_b32 v87, 0xffff0000, v67
    v_pk_fma_f32 v[80:81], v[80:81], v[240:241], v[232:233]
    v_pk_fma_f32 v[82:83], v[82:83], v[242:243], v[234:235]
    v_pk_fma_f32 v[84:85], v[84:85], v[244:245], v[236:237]
    v_pk_fma_f32 v[86:87], v[86:87], v[246:247], v[238:239]
    s_waitcnt lgkmcnt(1)
    v_lshlrev_b32 v88, 16, v104
    v_and_b32 v89, 0xffff0000, v104
    v_lshlrev_b32 v90, 16, v105
    v_and_b32 v91, 0xffff0000, v105
    v_lshlrev_b32 v92, 16, v106
    v_and_b32 v93, 0xffff0000, v106
    v_lshlrev_b32 v94, 16, v107
    v_and_b32 v95, 0xffff0000, v107
    s_waitcnt lgkmcnt(0)
    v_lshlrev_b32 v96, 16, v108
    v_and_b32 v97, 0xffff0000, v108
    v_lshlrev_b32 v98, 16, v109
    v_and_b32 v99, 0xffff0000, v109
    v_lshlrev_b32 v100, 16, v110
    v_and_b32 v101, 0xffff0000, v110
    v_lshlrev_b32 v102, 16, v111
    v_and_b32 v103, 0xffff0000, v111
    v_pk_add_f32 v[88:89], v[88:89], v[96:97]
    v_pk_add_f32 v[90:91], v[90:91], v[98:99]
    v_pk_add_f32 v[92:93], v[92:93], v[100:101]
    v_pk_add_f32 v[94:95], v[94:95], v[102:103]
    v_pk_fma_f32 v[80:81], v[88:89], v[60:61], v[80:81] op_sel:[0,1,0] op_sel_hi:[1,1,1]
    v_pk_fma_f32 v[82:83], v[90:91], v[60:61], v[82:83] op_sel:[0,1,0] op_sel_hi:[1,1,1]
    v_pk_fma_f32 v[84:85], v[92:93], v[60:61], v[84:85] op_sel:[0,1,0] op_sel_hi:[1,1,1]
    v_pk_fma_f32 v[86:87], v[94:95], v[60:61], v[86:87] op_sel:[0,1,0] op_sel_hi:[1,1,1]
    v_cvt_pk_bf16_f32 v64, v80, v81
    v_cvt_pk_bf16_f32 v65, v82, v83
    v_cvt_pk_bf16_f32 v66, v84, v85
    v_cvt_pk_bf16_f32 v67, v86, v87
    buffer_store_dwordx4 v[64:67], v46, s[48:51], s80 offen sc1
    s_endpgm
L_helper:
    v_lshrrev_b32 v3, 5, v1
    v_bfe_u32 v4, v1, 3, 2
    v_lshl_add_u32 v3, v3, 8, v4
    v_lshlrev_b32 v3, 10, v3
    v_and_b32 v5, 7, v1
    v_lshrrev_b32 v9, 4, v1
    v_xor_b32 v6, v5, v9
    v_lshl_add_u32 v10, v6, 4, v3
    v_xor_b32 v11, 64, v10
    s_lshr_b32 s64, s60, 2
    s_lshl_b32 s64, s64, 7
    s_and_b32 s65, s60, 3
    s_add_u32 s64, s64, s65
    s_lshl_b32 s64, s64, 12
    s_lshl_b32 s65, s57, 16
    s_add_u32 s68, s64, s65
    v_and_b32 v20, 15, v1
    v_lshlrev_b32 v6, 1, v9
    v_xor_b32 v6, v6, v20
    v_mul_u32_u24 v7, 3584, v9
    v_lshl_add_u32 v12, v6, 4, v7
    v_xor_b32 v13, 0x80, v12
    s_lshl_b32 s64, s61, 8
    s_mul_i32 s65, s57, 57344
    s_add_u32 s69, s64, s65
    s_lshl_b32 s70, s57, 12
    s_and_b32 s64, s59, 3
    s_lshr_b32 s65, s59, 2
    s_lshr_b32 s66, s58, 1
    s_add_u32 s65, s65, s66
    s_lshl_b32 s74, s64, 0
    s_add_u32 s74, s74, s65
    s_and_b32 s74, s74, 1
    s_add_u32 s74, s74, 1
    s_lshl_b32 s81, s64, 0
    s_add_u32 s81, s81, s65
    s_mul_i32 s66, s81, 52
    s_lshr_b32 s66, s66, 8
    s_mul_i32 s66, s66, 5
    s_sub_u32 s81, s81, s66
    s_add_u32 s81, s81, 3
    s_cmp_eq_u32 s82, 0
    s_waitcnt lgkmcnt(0)
    s_mov_b32 s28, s4
    s_mov_b32 s29, s5
    s_mov_b32 s30, 0x200000
    s_mov_b32 s31, 0x20000
    s_mov_b32 s32, s18
    s_mov_b32 s33, s19
    s_mov_b32 s34, 0x1c0000
    s_mov_b32 s35, 0x20000
    s_cbranch_scc1 L_spare_h0
    s_add_u32 s0, s68, 0
    s_add_u32 s1, s69, 0
    s_add_u32 m0, s70, 0
    s_add_u32 s3, s0, 0
    buffer_load_dwordx4 v10, s[28:31], s3 offen offset:0  lds
    s_add_u32 s3, s0, 15360
    buffer_load_dwordx4 v11, s[28:31], s3 offen offset:1024  lds
    s_add_u32 s3, s0, 30720
    buffer_load_dwordx4 v10, s[28:31], s3 offen offset:2048  lds
    s_add_u32 s3, s0, 46080
    buffer_load_dwordx4 v11, s[28:31], s3 offen offset:3072  lds
    s_add_u32 m0, s70, 16384
    s_add_u32 s3, s1, 0
    buffer_load_dwordx4 v12, s[32:35], s3 offen offset:0  lds
    s_add_u32 s3, s1, 13312
    buffer_load_dwordx4 v12, s[32:35], s3 offen offset:1024  lds
    s_add_u32 s3, s1, 26624
    buffer_load_dwordx4 v13, s[32:35], s3 offen offset:2048  lds
    s_add_u32 s3, s1, 39936
    buffer_load_dwordx4 v13, s[32:35], s3 offen offset:3072  lds
    s_lshl_b32 s0, s74, 7
    s_add_u32 s0, s0, s68
    s_mul_i32 s1, s74, 229376
    s_add_u32 s1, s1, s69
    s_add_u32 m0, s70, 32768
    s_add_u32 s3, s0, 0
    buffer_load_dwordx4 v10, s[28:31], s3 offen offset:0  lds
    s_cmp_eq_u32 s74, 2
    s_cselect_b32 s74, 0, s74
    s_add_u32 s74, s74, 1
    s_mov_b32 s64, 0xd40000
    s_load_dwordx2 s[52:53], s[26:27], s64
    s_mov_b32 s40, s20
    s_mov_b32 s41, s21
    s_mov_b32 s42, 0x1c0000
    s_mov_b32 s43, 0x20000
    s_mov_b32 s36, s26
    s_mov_b32 s37, s27
    s_mov_b32 s38, 0x1000000
    s_mov_b32 s39, 0x20000
    s_mov_b32 s48, s22
    s_mov_b32 s49, s23
    s_mov_b32 s50, 0x200000
    s_mov_b32 s51, 0x20000
    s_mov_b32 s44, s12
    s_mov_b32 s45, s13
    s_mov_b32 s46, 0x200000
    s_mov_b32 s47, 0x20000
    v_lshlrev_b32 v14, 4, v1
    v_mov_b32 v52, 0
    s_add_u32 s3, s0, 15360
    buffer_load_dwordx4 v11, s[28:31], s3 offen offset:1024  lds
    v_mov_b32 v53, 0
    v_mov_b32 v54, 0
    v_mov_b32 v55, 0
    v_lshrrev_b32 v3, 1, v20
    v_mul_u32_u24 v3, 4160, v3
    v_and_b32 v4, 1, v1
    v_lshl_add_u32 v3, v4, 4, v3
    v_add_u32 v3, 98304, v3
    ds_write_b128 v3, v[52:55]
    v_mov_b32 v3, 140800
    v_min_u32 v27, 1, v1
    v_lshlrev_b32 v27, 31, v27
    v_bfrev_b32 v4, 1
    ds_write2_b32 v3, v52, v4 offset0:2 offset1:3
    v_lshrrev_b32 v3, 3, v1
    v_lshlrev_b32 v4, 1, v9
    v_xor_b32 v4, v4, v5
    v_lshlrev_b32 v3, 10, v3
    v_lshl_add_u32 v24, v4, 4, v3
    s_lshl_b32 s64, s63, 7
    s_add_u32 s3, s0, 30720
    buffer_load_dwordx4 v10, s[28:31], s3 offen offset:2048  lds
    s_lshl_b32 s65, s57, 15
    s_add_u32 s73, s64, s65
    s_mov_b32 s20, 0
    s_lshl_b32 s64, s20, 17
    s_add_u32 s73, s73, s64
    v_add_u32 v15, s70, v14
    v_add_u32 v16, 0x10000, v15
    s_and_b32 s64, s56, 1
    s_lshl_b32 s64, s64, 2
    v_or_b32 v44, s64, v9
    v_xor_b32 v44, v44, v1
    s_lshl_b32 s64, s56, 10
    s_add_u32 s65, s64, 131072
    v_lshl_add_u32 v44, v44, 4, s65
    v_lshrrev_b32 v45, 3, v1
    v_and_b32 v46, 7, v1
    v_xor_b32 v47, v45, v46
    v_lshlrev_b32 v45, 7, v45
    s_add_u32 s65, s64, 147456
    s_add_u32 s3, s0, 46080
    buffer_load_dwordx4 v11, s[28:31], s3 offen offset:3072  lds
    v_lshl_add_u32 v45, v47, 4, v45
    v_add_u32 v45, s65, v45
    v_lshrrev_b32 v47, 5, v1
    v_lshlrev_b32 v47, 18, v47
    v_lshl_add_u32 v46, v46, 4, v47
    v_bfe_u32 v47, v1, 3, 2
    v_lshl_add_u32 v46, v47, 10, v46
    s_lshr_b32 s80, s62, 3
    s_lshl_b32 s80, s80, 9
    s_bfe_u32 s65, s62, 0x20001
    s_lshl_b32 s65, s65, 2
    s_add_u32 s80, s80, s65
    s_and_b32 s65, s62, 1
    s_lshl_b32 s65, s65, 7
    s_add_u32 s80, s80, s65
    s_lshl_b32 s65, s56, 4
    s_add_u32 s80, s80, s65
    s_lshl_b32 s80, s80, 10
    s_lshl_b32 s65, s63, 7
    s_add_u32 m0, s70, 49152
    s_add_u32 s3, s1, 0
    buffer_load_dwordx4 v12, s[32:35], s3 offen offset:0  lds
    s_add_u32 s80, s80, s65
    s_lshl_b32 s65, s56, 6
    s_add_u32 s65, s65, 140864
    v_and_b32 v47, 0x38, v1
    v_add_u32 v47, s65, v47
    s_lshl_b32 s79, s62, 9
    s_add_u32 s79, s79, 0xc00000
    s_lshl_b32 s64, s57, 5
    v_lshl_add_u32 v3, v9, 3, s64
    v_lshrrev_b32 v4, 1, v20
    v_lshlrev_b32 v4, 4, v4
    v_xor_b32 v3, v3, v4
    v_lshl_add_u32 v3, v20, 7, v3
    v_add_u32 v21, 131072, v3
    v_bfe_u32 v4, v1, 2, 2
    v_lshl_add_u32 v4, v9, 2, v4
    v_bfe_u32 v3, v4, 1, 2
    v_lshlrev_b32 v4, 7, v4
    v_and_b32 v6, 3, v1
    s_add_u32 s3, s1, 13312
    buffer_load_dwordx4 v12, s[32:35], s3 offen offset:1024  lds
    v_lshl_add_u32 v4, v6, 3, v4
    v_lshl_add_u32 v4, v3, 5, v4
    s_lshl_b32 s65, s57, 11
    s_add_u32 s65, s65, 139264
    v_add_u32 v22, s65, v4
    v_xor_b32 v40, 32, v22
    v_xor_b32 v41, 64, v22
    v_xor_b32 v42, 0x60, v22
    s_xor_b32 s64, s57, 1
    s_min_u32 s64, s64, 1
    s_lshl_b32 s64, s64, 31
    s_add_u32 s64, s64, 140864
    v_lshl_add_u32 v30, v1, 3, s64
    s_sub_u32 s79, s79, 140864
    s_lshl_b32 s64, s63, 2
    s_add_u32 s64, s64, s57
    s_lshr_b32 s65, s62, 4
    s_lshl_b32 s65, s65, 5
    s_add_u32 s65, s65, s64
    s_add_u32 s3, s1, 26624
    buffer_load_dwordx4 v13, s[32:35], s3 offen offset:2048  lds
    s_lshl_b32 s78, s65, 4
    s_lshl_b32 s78, s78, 3
    s_add_u32 s78, s78, 0xd20000
    s_lshl_b32 s64, s64, 11
    s_lshl_b32 s65, s62, 16
    s_add_u32 s64, s64, s65
    s_add_u32 s83, s64, 0x200000
    s_lshl_b32 s77, s62, 4
    s_add_u32 s77, s77, s20
    s_lshl_b32 s77, s77, 2
    s_mul_i32 s64, s57, 6
    s_add_u32 s77, s77, s64
    s_lshl_b32 s77, s77, 3
    s_add_u32 s77, s77, 0xd10000
    v_lshlrev_b32 v3, 5, v9
    v_xor_b32 v26, v3, v14
    s_lshl_b32 s72, s62, 3
    s_lshl_b32 s72, s72, 3
    s_add_u32 s72, s72, 0xd30000
    s_add_u32 s3, s1, 39936
    buffer_load_dwordx4 v13, s[32:35], s3 offen offset:3072  lds
    s_barrier
    s_waitcnt vmcnt(8) lgkmcnt(0)
    s_barrier
    s_lshl_b32 s0, s74, 7
    s_add_u32 s0, s0, s68
    s_mul_i32 s1, s74, 229376
    s_add_u32 s1, s1, s69
    s_add_u32 m0, s70, 65536
    s_add_u32 s3, s0, 0
    buffer_load_dwordx4 v10, s[28:31], s3 offen offset:0  lds
    s_mov_b32 s74, s81
    v_lshrrev_b32 v3, 5, v1
    s_add_u32 s3, s0, 15360
    buffer_load_dwordx4 v11, s[28:31], s3 offen offset:1024  lds
    v_mul_u32_u24 v3, 4608, v3
    s_add_u32 s3, s0, 30720
    buffer_load_dwordx4 v10, s[28:31], s3 offen offset:2048  lds
    v_and_b32 v4, 31, v1
    s_add_u32 s3, s0, 46080
    buffer_load_dwordx4 v11, s[28:31], s3 offen offset:3072  lds
    v_lshl_add_u32 v3, v4, 4, v3
    s_add_u32 m0, s70, 81920
    s_add_u32 s3, s1, 0
    buffer_load_dwordx4 v12, s[32:35], s3 offen offset:0  lds
    v_add_u32 v3, 135680, v3
    s_add_u32 s3, s1, 13312
    buffer_load_dwordx4 v12, s[32:35], s3 offen offset:1024  lds
    ds_write_b128 v3, v[52:55]
    s_add_u32 s3, s1, 26624
    buffer_load_dwordx4 v13, s[32:35], s3 offen offset:2048  lds
    s_add_u32 s3, s1, 39936
    buffer_load_dwordx4 v13, s[32:35], s3 offen offset:3072  lds
    s_waitcnt vmcnt(8)
    s_barrier
    s_lshl_b32 s0, s74, 7
    s_add_u32 s0, s0, s68
    s_mul_i32 s1, s74, 229376
    s_add_u32 s1, s1, s69
    s_add_u32 m0, s70, 0
    s_add_u32 s3, s0, 0
    buffer_load_dwordx4 v10, s[28:31], s3 offen offset:0  lds
    s_cmp_eq_u32 s74, 7
    s_cselect_b32 s74, 2, s74
    s_add_u32 s74, s74, 1
    s_add_u32 s3, s0, 15360
    buffer_load_dwordx4 v11, s[28:31], s3 offen offset:1024  lds
    s_add_u32 s3, s0, 30720
    buffer_load_dwordx4 v10, s[28:31], s3 offen offset:2048  lds
    s_add_u32 s3, s0, 46080
    buffer_load_dwordx4 v11, s[28:31], s3 offen offset:3072  lds
    s_add_u32 m0, s70, 16384
    s_add_u32 s3, s1, 0
    buffer_load_dwordx4 v12, s[32:35], s3 offen offset:0  lds
    s_add_u32 s3, s1, 13312
    buffer_load_dwordx4 v12, s[32:35], s3 offen offset:1024  lds
    s_add_u32 s3, s1, 26624
    buffer_load_dwordx4 v13, s[32:35], s3 offen offset:2048  lds
    s_add_u32 s3, s1, 39936
    buffer_load_dwordx4 v13, s[32:35], s3 offen offset:3072  lds
    s_waitcnt vmcnt(8)
    s_barrier
    s_lshl_b32 s0, s74, 7
    s_add_u32 s0, s0, s68
    s_mul_i32 s1, s74, 229376
    s_add_u32 s1, s1, s69
    s_add_u32 m0, s70, 32768
    s_add_u32 s3, s0, 0
    buffer_load_dwordx4 v10, s[28:31], s3 offen offset:0  lds
    s_cmp_eq_u32 s74, 7
    s_cselect_b32 s74, 2, s74
    s_add_u32 s74, s74, 1
    s_add_u32 s3, s0, 15360
    buffer_load_dwordx4 v11, s[28:31], s3 offen offset:1024  lds
    s_add_u32 s3, s0, 30720
    buffer_load_dwordx4 v10, s[28:31], s3 offen offset:2048  lds
    s_add_u32 s3, s0, 46080
    buffer_load_dwordx4 v11, s[28:31], s3 offen offset:3072  lds
    s_add_u32 m0, s70, 49152
    s_add_u32 s3, s1, 0
    buffer_load_dwordx4 v12, s[32:35], s3 offen offset:0  lds
    s_add_u32 s3, s1, 13312
    buffer_load_dwordx4 v12, s[32:35], s3 offen offset:1024  lds
    s_add_u32 s3, s1, 26624
    buffer_load_dwordx4 v13, s[32:35], s3 offen offset:2048  lds
    s_add_u32 s3, s1, 39936
    buffer_load_dwordx4 v13, s[32:35], s3 offen offset:3072  lds
    s_lshl_b32 s66, s71, 13
    s_lshl_b32 s65, s57, 11
    s_add_u32 s66, s66, s65
    s_lshr_b32 s64, s57, 1
    s_mul_i32 s64, s64, 12544
    s_add_u32 s64, s64, s65
    s_add_u32 m0, s64, 98336
    s_nop 0
    buffer_load_dwordx4 v14, s[44:47], s66 offen  lds
    buffer_load_dwordx4 v14, s[44:47], s66 offen offset:1024  lds
    s_waitcnt vmcnt(10)
    s_barrier
    s_lshl_b32 s0, s74, 7
    s_add_u32 s0, s0, s68
    s_mul_i32 s1, s74, 229376
    s_add_u32 s1, s1, s69
    s_add_u32 m0, s70, 65536
    s_add_u32 s3, s0, 0
    buffer_load_dwordx4 v10, s[28:31], s3 offen offset:0  lds
    s_cmp_eq_u32 s74, 7
    s_cselect_b32 s74, 2, s74
    s_add_u32 s74, s74, 1
    s_add_u32 s52, s52, 0x7f4a7c15
    s_add_u32 s3, s0, 15360
    buffer_load_dwordx4 v11, s[28:31], s3 offen offset:1024  lds
    s_add_u32 s53, s53, 0x9e3779b9
    s_add_u32 s3, s0, 30720
    buffer_load_dwordx4 v10, s[28:31], s3 offen offset:2048  lds
    v_mov_b32 v28, s52
    s_add_u32 s3, s0, 46080
    buffer_load_dwordx4 v11, s[28:31], s3 offen offset:3072  lds
    v_mov_b32 v29, s53
    s_add_u32 m0, s70, 81920
    s_add_u32 s3, s1, 0
    buffer_load_dwordx4 v12, s[32:35], s3 offen offset:0  lds
    s_add_u32 s3, s1, 13312
    buffer_load_dwordx4 v12, s[32:35], s3 offen offset:1024  lds
    s_add_u32 s3, s1, 26624
    buffer_load_dwordx4 v13, s[32:35], s3 offen offset:2048  lds
    s_add_u32 s3, s1, 39936
    buffer_load_dwordx4 v13, s[32:35], s3 offen offset:3072  lds
    s_waitcnt vmcnt(10)
    s_barrier
    s_lshl_b32 s0, s74, 7
    s_add_u32 s0, s0, s68
    s_mul_i32 s1, s74, 229376
    s_add_u32 s1, s1, s69
    s_add_u32 m0, s70, 0
    s_add_u32 s3, s0, 0
    buffer_load_dwordx4 v10, s[28:31], s3 offen offset:0  lds
    s_cmp_eq_u32 s74, 7
    s_cselect_b32 s74, 2, s74
    s_add_u32 s74, s74, 1
    s_add_u32 s3, s0, 15360
    buffer_load_dwordx4 v11, s[28:31], s3 offen offset:1024  lds
    s_add_u32 s3, s0, 30720
    buffer_load_dwordx4 v10, s[28:31], s3 offen offset:2048  lds
    s_add_u32 s3, s0, 46080
    buffer_load_dwordx4 v11, s[28:31], s3 offen offset:3072  lds
    s_add_u32 m0, s70, 16384
    s_add_u32 s3, s1, 0
    buffer_load_dwordx4 v12, s[32:35], s3 offen offset:0  lds
    s_add_u32 s3, s1, 13312
    buffer_load_dwordx4 v12, s[32:35], s3 offen offset:1024  lds
    s_add_u32 s3, s1, 26624
    buffer_load_dwordx4 v13, s[32:35], s3 offen offset:2048  lds
    s_add_u32 s3, s1, 39936
    buffer_load_dwordx4 v13, s[32:35], s3 offen offset:3072  lds
    s_lshr_b32 s64, s71, 3
    s_lshl_b32 s64, s64, 2
    s_add_u32 s64, s64, s57
    s_lshl_b32 s76, s64, 3
    s_lshl_b32 s76, s76, 3
    s_add_u32 s76, s76, 0xd00000
    s_load_dwordx16 s[4:19], s[26:27], s76 glc
    s_waitcnt vmcnt(8)
    s_barrier
    s_lshl_b32 s0, s74, 7
    s_add_u32 s0, s0, s68
    s_mul_i32 s1, s74, 229376
    s_add_u32 s1, s1, s69
    s_add_u32 m0, s70, 32768
    s_add_u32 s3, s0, 0
    buffer_load_dwordx4 v10, s[28:31], s3 offen offset:0  lds
    s_add_u32 s3, s0, 15360
    buffer_load_dwordx4 v11, s[28:31], s3 offen offset:1024  lds
    s_add_u32 s3, s0, 30720
    buffer_load_dwordx4 v10, s[28:31], s3 offen offset:2048  lds
    s_add_u32 s3, s0, 46080
    buffer_load_dwordx4 v11, s[28:31], s3 offen offset:3072  lds
    s_add_u32 m0, s70, 49152
    s_add_u32 s3, s1, 0
    buffer_load_dwordx4 v12, s[32:35], s3 offen offset:0  lds
    s_add_u32 s3, s1, 13312
    buffer_load_dwordx4 v12, s[32:35], s3 offen offset:1024  lds
    s_add_u32 s3, s1, 26624
    buffer_load_dwordx4 v13, s[32:35], s3 offen offset:2048  lds
    s_add_u32 s3, s1, 39936
    buffer_load_dwordx4 v13, s[32:35], s3 offen offset:3072  lds
    s_lshl_b32 s64, s71, 13
    s_lshl_b32 s65, s57, 10
    s_add_u32 s64, s64, s65
    s_add_u32 m0, s65, 131584
    s_mov_b32 s67, 0
L_pl_4:
    s_waitcnt lgkmcnt(0)
    s_cmp_lg_u64 s[4:5], s[52:53]
    s_cbranch_scc1 L_pr_5
    s_cmp_lg_u64 s[6:7], s[52:53]
    s_cbranch_scc1 L_pr_5
    s_cmp_lg_u64 s[8:9], s[52:53]
    s_cbranch_scc1 L_pr_5
    s_cmp_lg_u64 s[10:11], s[52:53]
    s_cbranch_scc1 L_pr_5
    s_cmp_lg_u64 s[12:13], s[52:53]
    s_cbranch_scc1 L_pr_5
    s_cmp_lg_u64 s[14:15], s[52:53]
    s_cbranch_scc1 L_pr_5
    s_cmp_lg_u64 s[16:17], s[52:53]
    s_cbranch_scc1 L_pr_5
    s_cmp_eq_u64 s[18:19], s[52:53]
    s_cbranch_scc1 L_pd_6
L_pr_5:
    s_add_u32 s67, s67, 1
    s_cmp_gt_u32 s67, 0x10000
    s_cbranch_scc1 L_pd_6
    s_load_dwordx16 s[4:19], s[26:27], s76 glc
    s_branch L_pl_4
L_pd_6:
    buffer_load_dwordx4 v14, s[36:39], s64 offen sc1 lds
    s_add_u32 m0, s65, 136192
    s_add_u32 s64, s64, 4096
    buffer_load_dwordx4 v14, s[36:39], s64 offen sc1 lds
    s_waitcnt vmcnt(10)
    s_barrier
    s_add_u32 m0, s70, 65536
    s_add_u32 s64, s73, 0
    buffer_load_dwordx4 v24, s[40:43], s64 offen offset:0 lds
    s_add_u32 s64, s73, 7168
    buffer_load_dwordx4 v24, s[40:43], s64 offen offset:1024 lds
    s_add_u32 s64, s73, 14336
    buffer_load_dwordx4 v24, s[40:43], s64 offen offset:2048 lds
    s_add_u32 s64, s73, 21504
    buffer_load_dwordx4 v24, s[40:43], s64 offen offset:3072 lds
    s_add_u32 m0, s70, 81920
    s_add_u32 s64, s73, 917504
    buffer_load_dwordx4 v24, s[40:43], s64 offen offset:0 lds
    s_add_u32 s64, s73, 924672
    buffer_load_dwordx4 v24, s[40:43], s64 offen offset:1024 lds
    s_add_u32 s64, s73, 931840
    buffer_load_dwordx4 v24, s[40:43], s64 offen offset:2048 lds
    s_add_u32 s64, s73, 939008
    buffer_load_dwordx4 v24, s[40:43], s64 offen offset:3072 lds
    s_waitcnt vmcnt(10)
    s_barrier
    s_waitcnt vmcnt(34)
    s_barrier
    s_lshl_b32 s64, s57, 10
    s_add_u32 s64, s64, 98328
    v_add_u32 v110, s64, v14
    s_waitcnt lgkmcnt(0)
    ds_read_b64 v[64:65], v110 offset:0
    ds_read_b128 v[66:69], v110 offset:8
    ds_read_b64 v[82:83], v110 offset:16640
    ds_read_b128 v[84:87], v110 offset:16648
    s_waitcnt lgkmcnt(2)
    v_alignbyte_b32 v70, v66, v65, 2
    v_alignbyte_b32 v71, v67, v66, 2
    v_alignbyte_b32 v72, v68, v67, 2
    v_alignbyte_b32 v73, v69, v68, 2
    v_mov_b32 v74, v65
    v_mov_b32 v75, v66
    v_mov_b32 v76, v67
    v_mov_b32 v77, v68
    v_alignbyte_b32 v78, v65, v64, 2
    v_alignbyte_b32 v79, v66, v65, 2
    v_alignbyte_b32 v80, v67, v66, 2
    v_alignbyte_b32 v81, v68, v67, 2
    s_waitcnt lgkmcnt(0)
    v_alignbyte_b32 v88, v84, v83, 2
    v_alignbyte_b32 v89, v85, v84, 2
    v_alignbyte_b32 v90, v86, v85, 2
    v_alignbyte_b32 v91, v87, v86, 2
    v_mov_b32 v92, v83
    v_mov_b32 v93, v84
    v_mov_b32 v94, v85
    v_mov_b32 v95, v86
    v_alignbyte_b32 v96, v83, v82, 2
    v_alignbyte_b32 v97, v84, v83, 2
    v_alignbyte_b32 v98, v85, v84, 2
    v_alignbyte_b32 v99, v86, v85, 2
    ds_write_b128 v110, v[70:73] offset:4168
    ds_write_b128 v110, v[74:77] offset:8328
    ds_write_b128 v110, v[78:81] offset:12488
    ds_write_b128 v110, v[88:91] offset:20808
    ds_write_b128 v110, v[92:95] offset:24968
    ds_write_b128 v110, v[96:99] offset:29128
    v_mov_b32 v3, 140800
    v_mov_b32 v4, 1
    s_waitcnt vmcnt(8) lgkmcnt(0)
    s_mov_b64 exec, 1
    ds_add_u32 v3, v4 offset:8
    s_mov_b64 exec, -1
L_h_join:
    s_cmp_lg_u32 s57, 1
    s_cbranch_scc1 L_w_7
    s_load_dwordx8 s[4:11], s[26:27], s72 glc
L_w_7:
    buffer_load_dwordx4 v[32:35], v46, s[28:31], s80 offen
    s_add_u32 m0, s70, 0
    s_add_u32 s64, s73, 131072
    buffer_load_dwordx4 v24, s[40:43], s64 offen offset:0 lds
    s_add_u32 s64, s73, 138240
    buffer_load_dwordx4 v24, s[40:43], s64 offen offset:1024 lds
    s_add_u32 s64, s73, 145408
    buffer_load_dwordx4 v24, s[40:43], s64 offen offset:2048 lds
    s_add_u32 s64, s73, 152576
    buffer_load_dwordx4 v24, s[40:43], s64 offen offset:3072 lds
    s_add_u32 m0, s70, 16384
    s_add_u32 s64, s73, 1048576
    buffer_load_dwordx4 v24, s[40:43], s64 offen offset:0 lds
    s_add_u32 s64, s73, 1055744
    buffer_load_dwordx4 v24, s[40:43], s64 offen offset:1024 lds
    s_add_u32 s64, s73, 1062912
    buffer_load_dwordx4 v24, s[40:43], s64 offen offset:2048 lds
    s_add_u32 s64, s73, 1070080
    buffer_load_dwordx4 v24, s[40:43], s64 offen offset:3072 lds
    s_add_u32 m0, s70, 32768
    s_add_u32 s64, s73, 262144
    buffer_load_dwordx4 v24, s[40:43], s64 offen offset:0 lds
    s_add_u32 s64, s73, 269312
    buffer_load_dwordx4 v24, s[40:43], s64 offen offset:1024 lds
    s_add_u32 s64, s73, 276480
    buffer_load_dwordx4 v24, s[40:43], s64 offen offset:2048 lds
    s_add_u32 s64, s73, 283648
    buffer_load_dwordx4 v24, s[40:43], s64 offen offset:3072 lds
    s_add_u32 m0, s70, 49152
    s_add_u32 s64, s73, 1179648
    buffer_load_dwordx4 v24, s[40:43], s64 offen offset:0 lds
    s_add_u32 s64, s73, 1186816
    buffer_load_dwordx4 v24, s[40:43], s64 offen offset:1024 lds
    s_add_u32 s64, s73, 1193984
    buffer_load_dwordx4 v24, s[40:43], s64 offen offset:2048 lds
    s_add_u32 s64, s73, 1201152
    buffer_load_dwordx4 v24, s[40:43], s64 offen offset:3072 lds
    s_cmp_lg_u32 s57, 1
    s_cbranch_scc1 L_w_8
    s_mov_b32 s67, 0
L_pl_9:
    s_waitcnt lgkmcnt(0)
    s_cmp_lg_u64 s[4:5], s[52:53]
    s_cbranch_scc1 L_pr_10
    s_cmp_lg_u64 s[6:7], s[52:53]
    s_cbranch_scc1 L_pr_10
    s_cmp_lg_u64 s[8:9], s[52:53]
    s_cbranch_scc1 L_pr_10
    s_cmp_eq_u64 s[10:11], s[52:53]
    s_cbranch_scc1 L_pd_11
L_pr_10:
    s_add_u32 s67, s67, 1
    s_cmp_gt_u32 s67, 0x10000
    s_cbranch_scc1 L_pd_11
    s_load_dwordx8 s[4:11], s[26:27], s72 glc
    s_branch L_pl_9
L_pd_11:
L_w_8:
    buffer_load_dwordx2 v[56:57], v30, s[36:39], s79 offen sc1
    s_add_u32 s64, s73, 393216
    buffer_load_dwordx4 v[120:123], v24, s[40:43], s64 offen
    s_add_u32 s64, s73, 401408
    buffer_load_dwordx4 v[124:127], v24, s[40:43], s64 offen
    s_add_u32 s64, s73, 409600
    buffer_load_dwordx4 v[128:131], v24, s[40:43], s64 offen
    s_add_u32 s64, s73, 417792
    buffer_load_dwordx4 v[132:135], v24, s[40:43], s64 offen
    s_add_u32 s64, s73, 1310720
    buffer_load_dwordx4 v[136:139], v24, s[40:43], s64 offen
    s_add_u32 s64, s73, 1318912
    buffer_load_dwordx4 v[140:143], v24, s[40:43], s64 offen
    s_add_u32 s64, s73, 1327104
    buffer_load_dwordx4 v[144:147], v24, s[40:43], s64 offen
    s_add_u32 s64, s73, 1335296
    buffer_load_dwordx4 v[148:151], v24, s[40:43], s64 offen
    s_add_u32 s64, s73, 524288
    buffer_load_dwordx4 v[152:155], v24, s[40:43], s64 offen
    s_add_u32 s64, s73, 532480
    buffer_load_dwordx4 v[156:159], v24, s[40:43], s64 offen
    s_add_u32 s64, s73, 540672
    buffer_load_dwordx4 v[160:163], v24, s[40:43], s64 offen
    s_add_u32 s64, s73, 548864
    buffer_load_dwordx4 v[164:167], v24, s[40:43], s64 offen
    s_add_u32 s64, s73, 1441792
    buffer_load_dwordx4 v[168:171], v24, s[40:43], s64 offen
    s_add_u32 s64, s73, 1449984
    buffer_load_dwordx4 v[172:175], v24, s[40:43], s64 offen
    s_add_u32 s64, s73, 1458176
    buffer_load_dwordx4 v[176:179], v24, s[40:43], s64 offen
    s_add_u32 s64, s73, 1466368
    buffer_load_dwordx4 v[180:183], v24, s[40:43], s64 offen
    s_cmp_lg_u32 s57, 0
    s_cbranch_scc1 L_w_12
    s_load_dwordx16 s[4:19], s[26:27], s77 glc
    s_add_u32 s66, s77, 64
    s_load_dwordx8 s[84:91], s[26:27], s66 glc
L_w_12:
    s_cmp_lg_u32 s57, 2
    s_cbranch_scc1 L_w_13
    s_load_dwordx16 s[4:19], s[26:27], s77 glc
    s_add_u32 s66, s77, 64
    s_load_dwordx16 s[84:99], s[26:27], s66 glc
L_w_13:
    s_add_u32 s64, s73, 655360
    buffer_load_dwordx4 v[184:187], v24, s[40:43], s64 offen
    s_add_u32 s64, s73, 663552
    buffer_load_dwordx4 v[188:191], v24, s[40:43], s64 offen
    s_add_u32 s64, s73, 671744
    buffer_load_dwordx4 v[192:195], v24, s[40:43], s64 offen
    s_add_u32 s64, s73, 679936
    buffer_load_dwordx4 v[196:199], v24, s[40:43], s64 offen
    s_add_u32 s64, s73, 1572864
    buffer_load_dwordx4 v[200:203], v24, s[40:43], s64 offen
    s_add_u32 s64, s73, 1581056
    buffer_load_dwordx4 v[204:207], v24, s[40:43], s64 offen
    s_add_u32 s64, s73, 1589248
    buffer_load_dwordx4 v[208:211], v24, s[40:43], s64 offen
    s_add_u32 s64, s73, 1597440
    buffer_load_dwordx4 v[212:215], v24, s[40:43], s64 offen
    s_waitcnt vmcnt(24)
    s_cmp_lg_u32 s57, 1
    s_cbranch_scc1 L_w_14
    ds_write_b64 v30, v[56:57] offset:0
    s_waitcnt lgkmcnt(0)
L_w_14:
L_h_join2:
    s_cmp_lg_u32 s57, 0
    s_cbranch_scc1 L_w_15
    s_mov_b32 s67, 0
L_pl_16:
    s_waitcnt lgkmcnt(0)
    s_cmp_lg_u64 s[4:5], s[52:53]
    s_cbranch_scc1 L_pr_17
    s_cmp_lg_u64 s[6:7], s[52:53]
    s_cbranch_scc1 L_pr_17
    s_cmp_lg_u64 s[8:9], s[52:53]
    s_cbranch_scc1 L_pr_17
    s_cmp_lg_u64 s[10:11], s[52:53]
    s_cbranch_scc1 L_pr_17
    s_cmp_lg_u64 s[12:13], s[52:53]
    s_cbranch_scc1 L_pr_17
    s_cmp_lg_u64 s[14:15], s[52:53]
    s_cbranch_scc1 L_pr_17
    s_cmp_lg_u64 s[16:17], s[52:53]
    s_cbranch_scc1 L_pr_17
    s_cmp_lg_u64 s[18:19], s[52:53]
    s_cbranch_scc1 L_pr_17
    s_cmp_lg_u64 s[84:85], s[52:53]
    s_cbranch_scc1 L_pr_17
    s_cmp_lg_u64 s[86:87], s[52:53]
    s_cbranch_scc1 L_pr_17
    s_cmp_lg_u64 s[88:89], s[52:53]
    s_cbranch_scc1 L_pr_17
    s_cmp_eq_u64 s[90:91], s[52:53]
    s_cbranch_scc1 L_pd_18
L_pr_17:
    s_add_u32 s67, s67, 1
    s_cmp_gt_u32 s67, 0x10000
    s_cbranch_scc1 L_pd_18
    s_load_dwordx16 s[4:19], s[26:27], s77 glc
    s_add_u32 s66, s77, 64
    s_load_dwordx8 s[84:91], s[26:27], s66 glc
    s_branch L_pl_16
L_pd_18:
    v_mov_b32 v3, 140800
    ds_write_b32 v3, v52 offset:12
L_w_15:
    s_waitcnt vmcnt(42)
    s_barrier
    s_waitcnt vmcnt(20)
    ds_write_b128 v16, v[120:123] offset:32768
    ds_write_b128 v16, v[124:127] offset:33792
    ds_write_b128 v16, v[128:131] offset:34816
    ds_write_b128 v16, v[132:135] offset:35840
    s_waitcnt vmcnt(16)
    ds_write_b128 v16, v[136:139] offset:49152
    ds_write_b128 v16, v[140:143] offset:50176
    ds_write_b128 v16, v[144:147] offset:51200
    ds_write_b128 v16, v[148:151] offset:52224
    s_cmp_lg_u32 s57, 2
    s_cbranch_scc1 L_w_19
    s_mov_b32 s67, 0
L_pl_20:
    s_waitcnt lgkmcnt(0)
    s_cmp_lg_u64 s[4:5], s[52:53]
    s_cbranch_scc1 L_pr_21
    s_cmp_lg_u64 s[6:7], s[52:53]
    s_cbranch_scc1 L_pr_21
    s_cmp_lg_u64 s[8:9], s[52:53]
    s_cbranch_scc1 L_pr_21
    s_cmp_lg_u64 s[10:11], s[52:53]
    s_cbranch_scc1 L_pr_21
    s_cmp_lg_u64 s[12:13], s[52:53]
    s_cbranch_scc1 L_pr_21
    s_cmp_lg_u64 s[14:15], s[52:53]
    s_cbranch_scc1 L_pr_21
    s_cmp_lg_u64 s[16:17], s[52:53]
    s_cbranch_scc1 L_pr_21
    s_cmp_lg_u64 s[18:19], s[52:53]
    s_cbranch_scc1 L_pr_21
    s_cmp_lg_u64 s[84:85], s[52:53]
    s_cbranch_scc1 L_pr_21
    s_cmp_lg_u64 s[86:87], s[52:53]
    s_cbranch_scc1 L_pr_21
    s_cmp_lg_u64 s[88:89], s[52:53]
    s_cbranch_scc1 L_pr_21
    s_cmp_lg_u64 s[90:91], s[52:53]
    s_cbranch_scc1 L_pr_21
    s_cmp_lg_u64 s[92:93], s[52:53]
    s_cbranch_scc1 L_pr_21
    s_cmp_lg_u64 s[94:95], s[52:53]
    s_cbranch_scc1 L_pr_21
    s_cmp_lg_u64 s[96:97], s[52:53]
    s_cbranch_scc1 L_pr_21
    s_cmp_eq_u64 s[98:99], s[52:53]
    s_cbranch_scc1 L_pd_22
L_pr_21:
    s_add_u32 s67, s67, 1
    s_cmp_gt_u32 s67, 0x10000
    s_cbranch_scc1 L_pd_22
    s_load_dwordx16 s[4:19], s[26:27], s77 glc
    s_add_u32 s66, s77, 64
    s_load_dwordx16 s[84:99], s[26:27], s66 glc
    s_branch L_pl_20
L_pd_22:
L_w_19:
    ds_read_b64 v[60:61], v47
    s_waitcnt vmcnt(41) lgkmcnt(0)
    v_mul_f32 v60, v60, v61
    v_lshlrev_b32 v232, 16, v32
    v_and_b32 v233, 0xffff0000, v32
    v_lshlrev_b32 v234, 16, v33
    v_and_b32 v235, 0xffff0000, v33
    v_lshlrev_b32 v236, 16, v34
    v_and_b32 v237, 0xffff0000, v34
    v_lshlrev_b32 v238, 16, v35
    v_and_b32 v239, 0xffff0000, v35
    v_fma_f32 v240, v232, v61, -v60
    v_fma_f32 v241, v233, v61, -v60
    v_fma_f32 v242, v234, v61, -v60
    v_fma_f32 v243, v235, v61, -v60
    v_fma_f32 v244, v236, v61, -v60
    v_fma_f32 v245, v237, v61, -v60
    v_fma_f32 v246, v238, v61, -v60
    v_fma_f32 v247, v239, v61, -v60
    s_waitcnt vmcnt(33)
    s_barrier
    s_waitcnt vmcnt(12)
    ds_write_b128 v16, v[152:155] offset:0
    ds_write_b128 v16, v[156:159] offset:1024
    ds_write_b128 v16, v[160:163] offset:2048
    ds_write_b128 v16, v[164:167] offset:3072
    s_waitcnt vmcnt(8)
    ds_write_b128 v16, v[168:171] offset:16384
    ds_write_b128 v16, v[172:175] offset:17408
    ds_write_b128 v16, v[176:179] offset:18432
    ds_write_b128 v16, v[180:183] offset:19456
    s_waitcnt vmcnt(25)
    s_barrier
    s_waitcnt vmcnt(4)
    ds_write_b128 v15, v[184:187] offset:0
    ds_write_b128 v15, v[188:191] offset:1024
    ds_write_b128 v15, v[192:195] offset:2048
    ds_write_b128 v15, v[196:199] offset:3072
    s_waitcnt vmcnt(0)
    ds_write_b128 v15, v[200:203] offset:16384
    ds_write_b128 v15, v[204:207] offset:17408
    ds_write_b128 v15, v[208:211] offset:18432
    ds_write_b128 v15, v[212:215] offset:19456
    s_waitcnt lgkmcnt(0)
    s_barrier
    s_add_u32 m0, s70, 32768
    s_add_u32 s64, s73, 786432
    buffer_load_dwordx4 v24, s[40:43], s64 offen offset:0 lds
    s_add_u32 s64, s73, 793600
    buffer_load_dwordx4 v24, s[40:43], s64 offen offset:1024 lds
    s_add_u32 s64, s73, 800768
    buffer_load_dwordx4 v24, s[40:43], s64 offen offset:2048 lds
    s_add_u32 s64, s73, 807936
    buffer_load_dwordx4 v24, s[40:43], s64 offen offset:3072 lds
    s_add_u32 m0, s70, 49152
    s_add_u32 s64, s73, 1703936
    buffer_load_dwordx4 v24, s[40:43], s64 offen offset:0 lds
    s_add_u32 s64, s73, 1711104
    buffer_load_dwordx4 v24, s[40:43], s64 offen offset:1024 lds
    s_add_u32 s64, s73, 1718272
    buffer_load_dwordx4 v24, s[40:43], s64 offen offset:2048 lds
    s_add_u32 s64, s73, 1725440
    buffer_load_dwordx4 v24, s[40:43], s64 offen offset:3072 lds
    s_load_dwordx16 s[4:19], s[26:27], s78 glc
    s_add_u32 s66, s78, 64
    s_load_dwordx16 s[84:99], s[26:27], s66 glc
    s_mov_b32 s67, 0
L_pl_23:
    s_waitcnt lgkmcnt(0)
    s_cmp_lg_u64 s[4:5], s[52:53]
    s_cbranch_scc1 L_pr_24
    s_cmp_lg_u64 s[6:7], s[52:53]
    s_cbranch_scc1 L_pr_24
    s_cmp_lg_u64 s[8:9], s[52:53]
    s_cbranch_scc1 L_pr_24
    s_cmp_lg_u64 s[10:11], s[52:53]
    s_cbranch_scc1 L_pr_24
    s_cmp_lg_u64 s[12:13], s[52:53]
    s_cbranch_scc1 L_pr_24
    s_cmp_lg_u64 s[14:15], s[52:53]
    s_cbranch_scc1 L_pr_24
    s_cmp_lg_u64 s[16:17], s[52:53]
    s_cbranch_scc1 L_pr_24
    s_cmp_lg_u64 s[18:19], s[52:53]
    s_cbranch_scc1 L_pr_24
    s_cmp_lg_u64 s[84:85], s[52:53]
    s_cbranch_scc1 L_pr_24
    s_cmp_lg_u64 s[86:87], s[52:53]
    s_cbranch_scc1 L_pr_24
    s_cmp_lg_u64 s[88:89], s[52:53]
    s_cbranch_scc1 L_pr_24
    s_cmp_lg_u64 s[90:91], s[52:53]
    s_cbranch_scc1 L_pr_24
    s_cmp_lg_u64 s[92:93], s[52:53]
    s_cbranch_scc1 L_pr_24
    s_cmp_lg_u64 s[94:95], s[52:53]
    s_cbranch_scc1 L_pr_24
    s_cmp_lg_u64 s[96:97], s[52:53]
    s_cbranch_scc1 L_pr_24
    s_cmp_eq_u64 s[98:99], s[52:53]
    s_cbranch_scc1 L_pd_25
L_pr_24:
    s_add_u32 s67, s67, 1
    s_cmp_gt_u32 s67, 0x10000
    s_cbranch_scc1 L_pd_25
    s_load_dwordx16 s[4:19], s[26:27], s78 glc
    s_add_u32 s66, s78, 64
    s_load_dwordx16 s[84:99], s[26:27], s66 glc
    s_branch L_pl_23
L_pd_25:
    s_lshl_b32 s64, s57, 11
    s_add_u32 m0, s64, 139264
    s_nop 0
    buffer_load_dwordx4 v26, s[36:39], s83 offen sc1 lds
    buffer_load_dwordx4 v26, s[36:39], s83 offen offset:1024 sc1 lds
    s_waitcnt vmcnt(2)
    s_barrier
    s_waitcnt vmcnt(0)
    ds_read_b64_tr_b16 v[72:73], v22
    ds_read_b64_tr_b16 v[74:75], v40
    ds_read_b64_tr_b16 v[76:77], v41
    ds_read_b64_tr_b16 v[78:79], v42
    s_waitcnt lgkmcnt(3)
    ds_write_b64 v21, v[72:73] offset:0
    s_waitcnt lgkmcnt(3)
    ds_write_b64 v21, v[74:75] offset:2048
    s_waitcnt lgkmcnt(3)
    ds_write_b64 v21, v[76:77] offset:4096
    s_waitcnt lgkmcnt(3)
    ds_write_b64 v21, v[78:79] offset:6144
L_tail:
    s_waitcnt vmcnt(0) lgkmcnt(0)
    s_barrier
    ds_read_b128 v[64:67], v44
    ds_read_b128 v[104:107], v45 offset:0
    ds_read_b128 v[108:111], v45 offset:8192
    s_waitcnt lgkmcnt(2)
    v_lshlrev_b32 v80, 16, v64
    v_and_b32 v81, 0xffff0000, v64
    v_lshlrev_b32 v82, 16, v65
    v_and_b32 v83, 0xffff0000, v65
    v_lshlrev_b32 v84, 16, v66
    v_and_b32 v85, 0xffff0000, v66
    v_lshlrev_b32 v86, 16, v67
    v_and_b32 v87, 0xffff0000, v67
    v_pk_fma_f32 v[80:81], v[80:81], v[240:241], v[232:233]
    v_pk_fma_f32 v[82:83], v[82:83], v[242:243], v[234:235]
    v_pk_fma_f32 v[84:85], v[84:85], v[244:245], v[236:237]
    v_pk_fma_f32 v[86:87], v[86:87], v[246:247], v[238:239]
    s_waitcnt lgkmcnt(1)
    v_lshlrev_b32 v88, 16, v104
    v_and_b32 v89, 0xffff0000, v104
    v_lshlrev_b32 v90, 16, v105
    v_and_b32 v91, 0xffff0000, v105
    v_lshlrev_b32 v92, 16, v106
    v_and_b32 v93, 0xffff0000, v106
    v_lshlrev_b32 v94, 16, v107
    v_and_b32 v95, 0xffff0000, v107
    s_waitcnt lgkmcnt(0)
    v_lshlrev_b32 v96, 16, v108
    v_and_b32 v97, 0xffff0000, v108
    v_lshlrev_b32 v98, 16, v109
    v_and_b32 v99, 0xffff0000, v109
    v_lshlrev_b32 v100, 16, v110
    v_and_b32 v101, 0xffff0000, v110
    v_lshlrev_b32 v102, 16, v111
    v_and_b32 v103, 0xffff0000, v111
    v_pk_add_f32 v[88:89], v[88:89], v[96:97]
    v_pk_add_f32 v[90:91], v[90:91], v[98:99]
    v_pk_add_f32 v[92:93], v[92:93], v[100:101]
    v_pk_add_f32 v[94:95], v[94:95], v[102:103]
    v_pk_fma_f32 v[80:81], v[88:89], v[60:61], v[80:81] op_sel:[0,1,0] op_sel_hi:[1,1,1]
    v_pk_fma_f32 v[82:83], v[90:91], v[60:61], v[82:83] op_sel:[0,1,0] op_sel_hi:[1,1,1]
    v_pk_fma_f32 v[84:85], v[92:93], v[60:61], v[84:85] op_sel:[0,1,0] op_sel_hi:[1,1,1]
    v_pk_fma_f32 v[86:87], v[94:95], v[60:61], v[86:87] op_sel:[0,1,0] op_sel_hi:[1,1,1]
    v_cvt_pk_bf16_f32 v64, v80, v81
    v_cvt_pk_bf16_f32 v65, v82, v83
    v_cvt_pk_bf16_f32 v66, v84, v85
    v_cvt_pk_bf16_f32 v67, v86, v87
    buffer_store_dwordx4 v[64:67], v46, s[48:51], s80 offen sc1
    s_endpgm
L_spare_m:
    s_waitcnt vmcnt(0)
    buffer_store_dwordx2 v[2:3], v28, s[36:39], s92 offen sc1
    s_setprio 0
    s_mov_b32 s28, s12
    s_mov_b32 s29, s13
    s_mov_b32 s30, 0x200000
    s_mov_b32 s31, 0x20000
    s_mov_b32 s32, s20
    s_mov_b32 s33, s21
    s_mov_b32 s34, 0x1c0000
    s_mov_b32 s35, 0x20000
    v_lshlrev_b32 v128, 7, v1
    v_lshrrev_b32 v129, 2, v1
    v_and_b32 v130, 3, v1
    v_lshlrev_b32 v129, 10, v129
    v_lshl_add_u32 v129, v130, 7, v129
    s_waitcnt lgkmcnt(0)
    s_barrier
    s_and_b32 s64, s59, 3
    s_and_b32 s65, s58, 6
    s_lshl_b32 s65, s65, 1
    s_add_u32 s64, s64, s65
    s_lshl_b32 s64, s64, 2
    s_add_u32 s64, s64, s57
    s_mul_i32 s64, s64, 56
    s_and_b32 s65, s58, 1
    s_add_u32 s64, s64, s65
    s_lshl_b32 s64, s64, 9
    s_add_u32 s65, s64, 12288
    buffer_load_dword v134, v129, s[32:35], s64 offen
    buffer_load_dword v135, v129, s[32:35], s65 offen
    s_xor_b32 s77, s57, 3
    s_or_b32 s77, s2, s77
    s_cbranch_scc1 L_te_28
    v_lshrrev_b32 v143, 3, v1
    v_and_b32 v144, 7, v1
    v_lshlrev_b32 v143, 10, v143
    v_lshl_add_u32 v143, v144, 5, v143
    s_mov_b32 s65, 0xd00000
    s_mov_b32 s67, 0
    buffer_load_dwordx4 v[144:147], v143, s[36:39], s65 offen sc1
    buffer_load_dwordx4 v[148:151], v143, s[36:39], s65 offen offset:16 sc1
L_te_28:
    s_barrier
    s_setprio 3
    s_waitcnt vmcnt(0)
    s_cmp_lg_u32 s77, 0
    s_cbranch_scc1 L_te_29
L_tl_26:
    v_cmp_ne_u64 vcc, v[144:145], v[2:3]
    v_cmp_ne_u64 s[90:91], v[146:147], v[2:3]
    s_or_b64 vcc, vcc, s[90:91]
    v_cmp_ne_u64 s[90:91], v[148:149], v[2:3]
    s_or_b64 vcc, vcc, s[90:91]
    v_cmp_ne_u64 s[90:91], v[150:151], v[2:3]
    s_or_b64 vcc, vcc, s[90:91]
    s_cbranch_scc0 L_td_27
    s_add_u32 s67, s67, 1
    s_cmp_gt_u32 s67, 0x10000
    s_cbranch_scc1 L_td_27
    buffer_load_dwordx4 v[144:147], v143, s[36:39], s65 offen sc1
    buffer_load_dwordx4 v[148:151], v143, s[36:39], s65 offen offset:16 sc1
    s_waitcnt vmcnt(0)
    s_branch L_tl_26
L_td_27:
    buffer_store_dwordx2 v[2:3], v28, s[36:39], s73 offen sc1
L_te_29:
    ds_read_b32 v27, v29 offset:8
    s_branch L_m_rchk
L_spare_h0:
    v_lshrrev_b32 v112, 5, v1
    v_bfe_u32 v113, v1, 3, 2
    v_lshl_add_u32 v112, v112, 8, v113
    v_and_b32 v114, 7, v1
    v_lshlrev_b32 v112, 10, v112
    v_lshl_add_u32 v112, v114, 4, v112
    s_and_b32 s64, s59, 3
    s_lshl_b32 s60, s58, 2
    s_add_u32 s60, s60, s64
    s_lshr_b32 s64, s60, 3
    s_lshl_b32 s64, s64, 9
    s_bfe_u32 s65, s60, 0x20001
    s_lshl_b32 s65, s65, 2
    s_add_u32 s64, s64, s65
    s_and_b32 s65, s60, 1
    s_lshl_b32 s65, s65, 7
    s_add_u32 s64, s64, s65
    s_lshl_b32 s65, s57, 5
    s_add_u32 s64, s64, s65
    s_lshl_b32 s64, s64, 10
    s_add_u32 s65, s64, 16384
    s_mov_b32 s0, s64
    s_mov_b32 s1, s65
    buffer_load_dwordx4 v[128:131], v112, s[28:31], s0 offen offset:0
    buffer_load_dwordx4 v[132:135], v112, s[28:31], s0 offen offset:128
    buffer_load_dwordx4 v[136:139], v112, s[28:31], s0 offen offset:256
    buffer_load_dwordx4 v[140:143], v112, s[28:31], s0 offen offset:384
    s_mov_b32 s64, 0xd40000
    s_load_dwordx2 s[52:53], s[26:27], s64
    s_mov_b32 s40, s20
    s_mov_b32 s41, s21
    s_mov_b32 s42, 0x1c0000
    s_mov_b32 s43, 0x20000
    s_mov_b32 s36, s26
    s_mov_b32 s37, s27
    s_mov_b32 s38, 0x1000000
    s_mov_b32 s39, 0x20000
    s_mov_b32 s48, s22
    s_mov_b32 s49, s23
    s_mov_b32 s50, 0x200000
    s_mov_b32 s51, 0x20000
    s_mov_b32 s44, s12
    s_mov_b32 s45, s13
    s_mov_b32 s46, 0x200000
    s_mov_b32 s47, 0x20000
    v_lshlrev_b32 v14, 4, v1
    v_mov_b32 v52, 0
    v_mov_b32 v53, 0
    v_mov_b32 v54, 0
    v_mov_b32 v55, 0
    v_lshrrev_b32 v3, 1, v20
    v_mul_u32_u24 v3, 4160, v3
    v_and_b32 v4, 1, v1
    v_lshl_add_u32 v3, v4, 4, v3
    v_add_u32 v3, 98304, v3
    ds_write_b128 v3, v[52:55]
    v_mov_b32 v3, 140800
    v_min_u32 v27, 1, v1
    v_lshlrev_b32 v27, 31, v27
    v_bfrev_b32 v4, 1
    ds_write2_b32 v3, v52, v4 offset0:2 offset1:3
    v_lshrrev_b32 v3, 3, v1
    v_lshlrev_b32 v4, 1, v9
    v_xor_b32 v4, v4, v5
    v_lshlrev_b32 v3, 10, v3
    v_lshl_add_u32 v24, v4, 4, v3
    s_lshl_b32 s64, s63, 7
    s_lshl_b32 s65, s57, 15
    s_add_u32 s73, s64, s65
    s_mov_b32 s20, 0
    s_lshl_b32 s64, s20, 17
    s_add_u32 s73, s73, s64
    v_add_u32 v15, s70, v14
    v_add_u32 v16, 0x10000, v15
    s_and_b32 s64, s56, 1
    s_lshl_b32 s64, s64, 2
    v_or_b32 v44, s64, v9
    v_xor_b32 v44, v44, v1
    s_lshl_b32 s64, s56, 10
    s_add_u32 s65, s64, 131072
    v_lshl_add_u32 v44, v44, 4, s65
    v_lshrrev_b32 v45, 3, v1
    v_and_b32 v46, 7, v1
    v_xor_b32 v47, v45, v46
    v_lshlrev_b32 v45, 7, v45
    s_add_u32 s65, s64, 147456
    v_lshl_add_u32 v45, v47, 4, v45
    v_add_u32 v45, s65, v45
    v_lshrrev_b32 v47, 5, v1
    v_lshlrev_b32 v47, 18, v47
    v_lshl_add_u32 v46, v46, 4, v47
    v_bfe_u32 v47, v1, 3, 2
    v_lshl_add_u32 v46, v47, 10, v46
    s_lshr_b32 s80, s62, 3
    s_lshl_b32 s80, s80, 9
    s_bfe_u32 s65, s62, 0x20001
    s_lshl_b32 s65, s65, 2
    s_add_u32 s80, s80, s65
    s_and_b32 s65, s62, 1
    s_lshl_b32 s65, s65, 7
    s_add_u32 s80, s80, s65
    s_lshl_b32 s65, s56, 4
    s_add_u32 s80, s80, s65
    s_lshl_b32 s80, s80, 10
    s_lshl_b32 s65, s63, 7
    s_add_u32 s80, s80, s65
    s_lshl_b32 s65, s56, 6
    s_add_u32 s65, s65, 140864
    v_and_b32 v47, 0x38, v1
    v_add_u32 v47, s65, v47
    s_lshl_b32 s79, s62, 9
    s_add_u32 s79, s79, 0xc00000
    s_lshl_b32 s64, s57, 5
    v_lshl_add_u32 v3, v9, 3, s64
    v_lshrrev_b32 v4, 1, v20
    v_lshlrev_b32 v4, 4, v4
    v_xor_b32 v3, v3, v4
    v_lshl_add_u32 v3, v20, 7, v3
    v_add_u32 v21, 131072, v3
    v_bfe_u32 v4, v1, 2, 2
    v_lshl_add_u32 v4, v9, 2, v4
    v_bfe_u32 v3, v4, 1, 2
    v_lshlrev_b32 v4, 7, v4
    v_and_b32 v6, 3, v1
    v_lshl_add_u32 v4, v6, 3, v4
    v_lshl_add_u32 v4, v3, 5, v4
    s_lshl_b32 s65, s57, 11
    s_add_u32 s65, s65, 139264
    v_add_u32 v22, s65, v4
    v_xor_b32 v40, 32, v22
    v_xor_b32 v41, 64, v22
    v_xor_b32 v42, 0x60, v22
    s_xor_b32 s64, s57, 1
    s_min_u32 s64, s64, 1
    s_lshl_b32 s64, s64, 31
    s_add_u32 s64, s64, 140864
    v_lshl_add_u32 v30, v1, 3, s64
    s_sub_u32 s79, s79, 140864
    s_lshl_b32 s64, s63, 2
    s_add_u32 s64, s64, s57
    s_lshr_b32 s65, s62, 4
    s_lshl_b32 s65, s65, 5
    s_add_u32 s65, s65, s64
    s_lshl_b32 s78, s65, 4
    s_lshl_b32 s78, s78, 3
    s_add_u32 s78, s78, 0xd20000
    s_lshl_b32 s64, s64, 11
    s_lshl_b32 s65, s62, 16
    s_add_u32 s64, s64, s65
    s_add_u32 s83, s64, 0x200000
    s_lshl_b32 s77, s62, 4
    s_add_u32 s77, s77, s20
    s_lshl_b32 s77, s77, 2
    s_mul_i32 s64, s57, 6
    s_add_u32 s77, s77, s64
    s_lshl_b32 s77, s77, 3
    s_add_u32 s77, s77, 0xd10000
    v_lshlrev_b32 v3, 5, v9
    v_xor_b32 v26, v3, v14
    s_lshl_b32 s72, s62, 3
    s_lshl_b32 s72, s72, 3
    s_add_u32 s72, s72, 0xd30000
    buffer_load_dwordx4 v[144:147], v112, s[28:31], s0 offen offset:512
    buffer_load_dwordx4 v[148:151], v112, s[28:31], s0 offen offset:640
    buffer_load_dwordx4 v[152:155], v112, s[28:31], s0 offen offset:768
    buffer_load_dwordx4 v[156:159], v112, s[28:31], s0 offen offset:896
    s_barrier
    buffer_load_dwordx4 v[160:163], v112, s[28:31], s1 offen offset:0
    buffer_load_dwordx4 v[164:167], v112, s[28:31], s1 offen offset:128
    buffer_load_dwordx4 v[168:171], v112, s[28:31], s1 offen offset:256
    buffer_load_dwordx4 v[172:175], v112, s[28:31], s1 offen offset:384
    buffer_load_dwordx4 v[176:179], v112, s[28:31], s1 offen offset:512
    buffer_load_dwordx4 v[180:183], v112, s[28:31], s1 offen offset:640
    buffer_load_dwordx4 v[184:187], v112, s[28:31], s1 offen offset:768
    buffer_load_dwordx4 v[188:191], v112, s[28:31], s1 offen offset:896
    s_setprio 1
    s_waitcnt lgkmcnt(0)
    s_barrier
    s_lshl_b32 s66, s71, 13
    s_lshl_b32 s65, s57, 11
    s_add_u32 s66, s66, s65
    s_lshr_b32 s64, s57, 1
    s_mul_i32 s64, s64, 12544
    s_add_u32 s64, s64, s65
    s_add_u32 m0, s64, 98336
    s_nop 0
    buffer_load_dwordx4 v14, s[44:47], s66 offen  lds
    buffer_load_dwordx4 v14, s[44:47], s66 offen offset:1024  lds
    v_mov_b32 v100, 0
    v_mov_b32 v101, 0
    v_mov_b32 v102, 0
    v_mov_b32 v103, 0
    v_mov_b32 v104, 0
    v_mov_b32 v105, 0
    v_mov_b32 v106, 0
    v_mov_b32 v107, 0
    s_mov_b32 s64, 0x3f803f80
    s_waitcnt vmcnt(17)
    v_dot2c_f32_bf16 v100, s64, v128
    v_dot2c_f32_bf16 v102, v128, v128
    v_dot2c_f32_bf16 v101, s64, v129
    v_dot2c_f32_bf16 v103, v129, v129
    v_dot2c_f32_bf16 v100, s64, v130
    v_dot2c_f32_bf16 v102, v130, v130
    v_dot2c_f32_bf16 v101, s64, v131
    v_dot2c_f32_bf16 v103, v131, v131
    s_waitcnt vmcnt(16)
    v_dot2c_f32_bf16 v100, s64, v132
    v_dot2c_f32_bf16 v102, v132, v132
    v_dot2c_f32_bf16 v101, s64, v133
    v_dot2c_f32_bf16 v103, v133, v133
    v_dot2c_f32_bf16 v100, s64, v134
    v_dot2c_f32_bf16 v102, v134, v134
    v_dot2c_f32_bf16 v101, s64, v135
    v_dot2c_f32_bf16 v103, v135, v135
    s_waitcnt vmcnt(15)
    v_dot2c_f32_bf16 v100, s64, v136
    v_dot2c_f32_bf16 v102, v136, v136
    v_dot2c_f32_bf16 v101, s64, v137
    v_dot2c_f32_bf16 v103, v137, v137
    v_dot2c_f32_bf16 v100, s64, v138
    v_dot2c_f32_bf16 v102, v138, v138
    v_dot2c_f32_bf16 v101, s64, v139
    v_dot2c_f32_bf16 v103, v139, v139
    s_waitcnt vmcnt(14)
    v_dot2c_f32_bf16 v100, s64, v140
    v_dot2c_f32_bf16 v102, v140, v140
    v_dot2c_f32_bf16 v101, s64, v141
    v_dot2c_f32_bf16 v103, v141, v141
    v_dot2c_f32_bf16 v100, s64, v142
    v_dot2c_f32_bf16 v102, v142, v142
    v_dot2c_f32_bf16 v101, s64, v143
    v_dot2c_f32_bf16 v103, v143, v143
    s_waitcnt vmcnt(13)
    v_dot2c_f32_bf16 v100, s64, v144
    v_dot2c_f32_bf16 v102, v144, v144
    v_dot2c_f32_bf16 v101, s64, v145
    v_dot2c_f32_bf16 v103, v145, v145
    v_dot2c_f32_bf16 v100, s64, v146
    v_dot2c_f32_bf16 v102, v146, v146
    v_dot2c_f32_bf16 v101, s64, v147
    v_dot2c_f32_bf16 v103, v147, v147
    s_waitcnt vmcnt(12)
    v_dot2c_f32_bf16 v100, s64, v148
    v_dot2c_f32_bf16 v102, v148, v148
    v_dot2c_f32_bf16 v101, s64, v149
    v_dot2c_f32_bf16 v103, v149, v149
    v_dot2c_f32_bf16 v100, s64, v150
    v_dot2c_f32_bf16 v102, v150, v150
    v_dot2c_f32_bf16 v101, s64, v151
    v_dot2c_f32_bf16 v103, v151, v151
    s_waitcnt vmcnt(11)
    v_dot2c_f32_bf16 v100, s64, v152
    v_dot2c_f32_bf16 v102, v152, v152
    v_dot2c_f32_bf16 v101, s64, v153
    v_dot2c_f32_bf16 v103, v153, v153
    v_dot2c_f32_bf16 v100, s64, v154
    v_dot2c_f32_bf16 v102, v154, v154
    v_dot2c_f32_bf16 v101, s64, v155
    v_dot2c_f32_bf16 v103, v155, v155
    s_waitcnt vmcnt(10)
    v_dot2c_f32_bf16 v100, s64, v156
    v_dot2c_f32_bf16 v102, v156, v156
    v_dot2c_f32_bf16 v101, s64, v157
    v_dot2c_f32_bf16 v103, v157, v157
    v_dot2c_f32_bf16 v100, s64, v158
    v_dot2c_f32_bf16 v102, v158, v158
    v_dot2c_f32_bf16 v101, s64, v159
    v_dot2c_f32_bf16 v103, v159, v159
    s_waitcnt vmcnt(9)
    v_dot2c_f32_bf16 v104, s64, v160
    v_dot2c_f32_bf16 v106, v160, v160
    v_dot2c_f32_bf16 v105, s64, v161
    v_dot2c_f32_bf16 v107, v161, v161
    v_dot2c_f32_bf16 v104, s64, v162
    v_dot2c_f32_bf16 v106, v162, v162
    v_dot2c_f32_bf16 v105, s64, v163
    v_dot2c_f32_bf16 v107, v163, v163
    s_waitcnt vmcnt(8)
    v_dot2c_f32_bf16 v104, s64, v164
    v_dot2c_f32_bf16 v106, v164, v164
    v_dot2c_f32_bf16 v105, s64, v165
    v_dot2c_f32_bf16 v107, v165, v165
    v_dot2c_f32_bf16 v104, s64, v166
    v_dot2c_f32_bf16 v106, v166, v166
    v_dot2c_f32_bf16 v105, s64, v167
    v_dot2c_f32_bf16 v107, v167, v167
    s_waitcnt vmcnt(7)
    v_dot2c_f32_bf16 v104, s64, v168
    v_dot2c_f32_bf16 v106, v168, v168
    v_dot2c_f32_bf16 v105, s64, v169
    v_dot2c_f32_bf16 v107, v169, v169
    v_dot2c_f32_bf16 v104, s64, v170
    v_dot2c_f32_bf16 v106, v170, v170
    v_dot2c_f32_bf16 v105, s64, v171
    v_dot2c_f32_bf16 v107, v171, v171
    s_waitcnt vmcnt(6)
    v_dot2c_f32_bf16 v104, s64, v172
    v_dot2c_f32_bf16 v106, v172, v172
    v_dot2c_f32_bf16 v105, s64, v173
    v_dot2c_f32_bf16 v107, v173, v173
    v_dot2c_f32_bf16 v104, s64, v174
    v_dot2c_f32_bf16 v106, v174, v174
    v_dot2c_f32_bf16 v105, s64, v175
    v_dot2c_f32_bf16 v107, v175, v175
    s_waitcnt vmcnt(5)
    v_dot2c_f32_bf16 v104, s64, v176
    v_dot2c_f32_bf16 v106, v176, v176
    v_dot2c_f32_bf16 v105, s64, v177
    v_dot2c_f32_bf16 v107, v177, v177
    v_dot2c_f32_bf16 v104, s64, v178
    v_dot2c_f32_bf16 v106, v178, v178
    v_dot2c_f32_bf16 v105, s64, v179
    v_dot2c_f32_bf16 v107, v179, v179
    s_waitcnt vmcnt(4)
    v_dot2c_f32_bf16 v104, s64, v180
    v_dot2c_f32_bf16 v106, v180, v180
    v_dot2c_f32_bf16 v105, s64, v181
    v_dot2c_f32_bf16 v107, v181, v181
    v_dot2c_f32_bf16 v104, s64, v182
    v_dot2c_f32_bf16 v106, v182, v182
    v_dot2c_f32_bf16 v105, s64, v183
    v_dot2c_f32_bf16 v107, v183, v183
    s_waitcnt vmcnt(3)
    v_dot2c_f32_bf16 v104, s64, v184
    v_dot2c_f32_bf16 v106, v184, v184
    v_dot2c_f32_bf16 v105, s64, v185
    v_dot2c_f32_bf16 v107, v185, v185
    v_dot2c_f32_bf16 v104, s64, v186
    v_dot2c_f32_bf16 v106, v186, v186
    v_dot2c_f32_bf16 v105, s64, v187
    v_dot2c_f32_bf16 v107, v187, v187
    s_waitcnt vmcnt(2)
    v_dot2c_f32_bf16 v104, s64, v188
    v_dot2c_f32_bf16 v106, v188, v188
    v_dot2c_f32_bf16 v105, s64, v189
    v_dot2c_f32_bf16 v107, v189, v189
    v_dot2c_f32_bf16 v104, s64, v190
    v_dot2c_f32_bf16 v106, v190, v190
    v_dot2c_f32_bf16 v105, s64, v191
    v_dot2c_f32_bf16 v107, v191, v191
    v_add_f32 v100, v100, v101
    v_add_f32 v101, v102, v103
    v_add_f32 v102, v104, v105
    v_add_f32 v103, v106, v107
    s_nop 0
    v_add_f32_dpp v100, v100, v100 quad_perm:[1,0,3,2] row_mask:0xf bank_mask:0xf
    v_add_f32_dpp v101, v101, v101 quad_perm:[1,0,3,2] row_mask:0xf bank_mask:0xf
    v_add_f32_dpp v102, v102, v102 quad_perm:[1,0,3,2] row_mask:0xf bank_mask:0xf
    v_add_f32_dpp v103, v103, v103 quad_perm:[1,0,3,2] row_mask:0xf bank_mask:0xf
    v_add_f32_dpp v100, v100, v100 quad_perm:[2,3,0,1] row_mask:0xf bank_mask:0xf
    v_add_f32_dpp v101, v101, v101 quad_perm:[2,3,0,1] row_mask:0xf bank_mask:0xf
    v_add_f32_dpp v102, v102, v102 quad_perm:[2,3,0,1] row_mask:0xf bank_mask:0xf
    v_add_f32_dpp v103, v103, v103 quad_perm:[2,3,0,1] row_mask:0xf bank_mask:0xf
    v_add_f32_dpp v100, v100, v100 row_half_mirror row_mask:0xf bank_mask:0xf
    v_add_f32_dpp v101, v101, v101 row_half_mirror row_mask:0xf bank_mask:0xf
    v_add_f32_dpp v102, v102, v102 row_half_mirror row_mask:0xf bank_mask:0xf
    v_add_f32_dpp v103, v103, v103 row_half_mirror row_mask:0xf bank_mask:0xf
    v_cmp_eq_u32 vcc, 1, v114
    v_lshrrev_b32 v113, 3, v1
    v_lshl_add_u32 v113, v114, 3, v113
    v_cndmask_b32 v100, v100, v102, vcc
    v_cndmask_b32 v101, v101, v103, vcc
    v_mul_f32 v100, 0x3b000000, v100
    v_mul_f32 v101, 0x3b000000, v101
    v_fma_f32 v101, -v100, v100, v101
    v_max_f32 v101, 0, v101
    v_cvt_pk_bf16_f32 v102, v100, v101
    v_lshlrev_b32 v100, 16, v102
    v_and_b32 v101, 0xffff0000, v102
    v_add_f32 v101, 0x3727c5ac, v101
    v_cvt_pk_bf16_f32 v101, v101, v101
    v_lshlrev_b32 v101, 16, v101
    v_sqrt_f32 v101, v101
    v_cmp_gt_u32 vcc, 2, v114
    v_lshlrev_b32 v113, 3, v113
    v_mov_b32 v115, 0x80000000
    v_cvt_pk_bf16_f32 v101, v101, v101
    v_lshlrev_b32 v101, 16, v101
    v_rcp_f32 v101, v101
    v_cndmask_b32 v113, v115, v113, vcc
    s_lshl_b32 s64, s60, 2
    s_add_u32 s64, s64, s57
    s_lshl_b32 s64, s64, 7
    s_add_u32 s64, s64, 0xc00000
    buffer_store_dwordx2 v[100:101], v113, s[36:39], s64 offen sc1
    s_lshl_b32 s60, s60, 3
    s_add_u32 s60, s60, s57
    s_lshl_b32 s60, s60, 3
    s_add_u32 s60, s60, 0xd30000
    s_waitcnt vmcnt(1) lgkmcnt(0)
    s_barrier
    s_add_u32 s52, s52, 0x7f4a7c15
    s_add_u32 s53, s53, 0x9e3779b9
    v_mov_b32 v28, s52
    v_mov_b32 v29, s53
    v_lshrrev_b32 v3, 5, v1
    v_mul_u32_u24 v3, 4608, v3
    v_and_b32 v4, 31, v1
    v_lshl_add_u32 v3, v4, 4, v3
    v_add_u32 v3, 135680, v3
    ds_write_b128 v3, v[52:55]
    s_lshl_b32 s64, s57, 10
    s_add_u32 s64, s64, 98328
    v_add_u32 v110, s64, v14
    s_waitcnt lgkmcnt(0)
    ds_read_b64 v[64:65], v110 offset:0
    ds_read_b128 v[66:69], v110 offset:8
    ds_read_b64 v[82:83], v110 offset:16640
    ds_read_b128 v[84:87], v110 offset:16648
    s_waitcnt lgkmcnt(2)
    v_alignbyte_b32 v70, v66, v65, 2
    v_alignbyte_b32 v71, v67, v66, 2
    v_alignbyte_b32 v72, v68, v67, 2
    v_alignbyte_b32 v73, v69, v68, 2
    v_mov_b32 v74, v65
    v_mov_b32 v75, v66
    v_mov_b32 v76, v67
    v_mov_b32 v77, v68
    v_alignbyte_b32 v78, v65, v64, 2
    v_alignbyte_b32 v79, v66, v65, 2
    v_alignbyte_b32 v80, v67, v66, 2
    v_alignbyte_b32 v81, v68, v67, 2
    s_waitcnt lgkmcnt(0)
    v_alignbyte_b32 v88, v84, v83, 2
    v_alignbyte_b32 v89, v85, v84, 2
    v_alignbyte_b32 v90, v86, v85, 2
    v_alignbyte_b32 v91, v87, v86, 2
    v_mov_b32 v92, v83
    v_mov_b32 v93, v84
    v_mov_b32 v94, v85
    v_mov_b32 v95, v86
    v_alignbyte_b32 v96, v83, v82, 2
    v_alignbyte_b32 v97, v84, v83, 2
    v_alignbyte_b32 v98, v85, v84, 2
    v_alignbyte_b32 v99, v86, v85, 2
    ds_write_b128 v110, v[70:73] offset:4168
    ds_write_b128 v110, v[74:77] offset:8328
    ds_write_b128 v110, v[78:81] offset:12488
    ds_write_b128 v110, v[88:91] offset:20808
    ds_write_b128 v110, v[92:95] offset:24968
    ds_write_b128 v110, v[96:99] offset:29128
    s_waitcnt vmcnt(0)
    buffer_store_dwordx2 v[28:29], v27, s[36:39], s60 offen sc1
    s_lshr_b32 s64, s71, 3
    s_lshl_b32 s64, s64, 2
    s_add_u32 s64, s64, s57
    s_lshl_b32 s76, s64, 3
    s_lshl_b32 s76, s76, 3
    s_add_u32 s76, s76, 0xd00000
    s_load_dwordx16 s[4:19], s[26:27], s76 glc
    s_lshl_b32 s64, s71, 13
    s_lshl_b32 s65, s57, 10
    s_add_u32 s64, s64, s65
    s_add_u32 m0, s65, 131584
    s_mov_b32 s67, 0
L_pl_30:
    s_waitcnt lgkmcnt(0)
    s_cmp_lg_u64 s[4:5], s[52:53]
    s_cbranch_scc1 L_pr_31
    s_cmp_lg_u64 s[6:7], s[52:53]
    s_cbranch_scc1 L_pr_31
    s_cmp_lg_u64 s[8:9], s[52:53]
    s_cbranch_scc1 L_pr_31
    s_cmp_lg_u64 s[10:11], s[52:53]
    s_cbranch_scc1 L_pr_31
    s_cmp_lg_u64 s[12:13], s[52:53]
    s_cbranch_scc1 L_pr_31
    s_cmp_lg_u64 s[14:15], s[52:53]
    s_cbranch_scc1 L_pr_31
    s_cmp_lg_u64 s[16:17], s[52:53]
    s_cbranch_scc1 L_pr_31
    s_cmp_eq_u64 s[18:19], s[52:53]
    s_cbranch_scc1 L_pd_32
L_pr_31:
    s_add_u32 s67, s67, 1
    s_cmp_gt_u32 s67, 0x10000
    s_cbranch_scc1 L_pd_32
    s_load_dwordx16 s[4:19], s[26:27], s76 glc
    s_branch L_pl_30
L_pd_32:
    buffer_load_dwordx4 v14, s[36:39], s64 offen sc1 lds
    s_add_u32 m0, s65, 136192
    s_add_u32 s64, s64, 4096
    buffer_load_dwordx4 v14, s[36:39], s64 offen sc1 lds
    s_waitcnt lgkmcnt(0)
    s_barrier
    s_setprio 0
    v_mov_b32 v3, 140800
    v_mov_b32 v4, 1
    s_waitcnt vmcnt(0) lgkmcnt(0)
    s_mov_b64 exec, 1
    ds_add_u32 v3, v4 offset:8
    s_mov_b64 exec, -1
    s_add_u32 m0, s70, 65536
    s_add_u32 s64, s73, 0
    buffer_load_dwordx4 v24, s[40:43], s64 offen offset:0 lds
    s_add_u32 s64, s73, 7168
    buffer_load_dwordx4 v24, s[40:43], s64 offen offset:1024 lds
    s_add_u32 s64, s73, 14336
    buffer_load_dwordx4 v24, s[40:43], s64 offen offset:2048 lds
    s_add_u32 s64, s73, 21504
    buffer_load_dwordx4 v24, s[40:43], s64 offen offset:3072 lds
    s_add_u32 m0, s70, 81920
    s_add_u32 s64, s73, 917504
    buffer_load_dwordx4 v24, s[40:43], s64 offen offset:0 lds
    s_add_u32 s64, s73, 924672
    buffer_load_dwordx4 v24, s[40:43], s64 offen offset:1024 lds
    s_add_u32 s64, s73, 931840
    buffer_load_dwordx4 v24, s[40:43], s64 offen offset:2048 lds
    s_add_u32 s64, s73, 939008
    buffer_load_dwordx4 v24, s[40:43], s64 offen offset:3072 lds
    s_branch L_h_join
L_end:
s_endpgm
.section .rodata,"a"
.p2align 6
.amdhsa_kernel parallel_sum__ssm_conv_h3__dense_activation_relu__prompt_kernel
  .amdhsa_next_free_vgpr 256
  .amdhsa_next_free_sgpr 102
  .amdhsa_accum_offset 256
  .amdhsa_group_segment_fixed_size 0
  .amdhsa_kernarg_size 96
  .amdhsa_user_sgpr_count 2
  .amdhsa_user_sgpr_kernarg_segment_ptr 1
  .amdhsa_system_sgpr_workgroup_id_x 1
.end_amdhsa_kernel
```
